```python
import torch

def _softmax(x, axis=-1):
    return torch.softmax(x, dim=axis)
def _gelu(x):
    return torch.nn.functional.gelu(x, approximate="tanh")
def _silu(x):
    return torch.nn.functional.silu(x)
def _sigmoid(x):
    return torch.sigmoid(x)
def _layernorm(x, axis=-1, eps=1e-5):
    m = x.mean(dim=axis, keepdim=True)
    v = x.var(dim=axis, keepdim=True, unbiased=False)
    return (x - m) / torch.sqrt(v + eps)
def _scatter_add(tgt, idx, src, axis=0):
    return tgt.clone().index_add_(axis, idx, src)
def _segment_sum(src, seg, n):
    out = torch.zeros((n,) + src.shape[1:], dtype=src.dtype)
    return out.index_add_(0, seg, src)
def _pad(x, pw):
    flat = tuple(v for pair in reversed(pw) for v in pair)
    return torch.nn.functional.pad(x, flat)

kernel_name = 'sequential_preLN__sliding_block_cached__mixer_channel_mlp__decode'

def setup_inputs():

    _w = (lambda a: (lambda t: t.to(torch.bfloat16) if t.is_floating_point() else t)(torch.as_tensor(a)))
    def _A_setup():
        B, Sq, D = 8, 1, 512
        Hq, Hkv, Sk, Dh = 32, 8, 4096, 128
        assert Hq % Hkv == 0, (Hq, Hkv)
        return {
            "x": _w((lambda *s: torch.randn(*s, dtype=torch.bfloat16) * 0.05)(B, Sq, D)),
            "k_cache": _w((lambda *s: torch.randn(*s, dtype=torch.bfloat16) * 3.2)(B, Hkv, Sk, Dh)),
            "v_cache": _w((lambda *s: torch.randn(*s, dtype=torch.bfloat16) * 0.4)(B, Hkv, Sk, Dh)),
            "wq": _w((lambda *s: torch.randn(*s, dtype=torch.bfloat16) * 3.2)(D, Hq * Dh) * (D ** -0.5)),
            "wo": _w((lambda *s: torch.randn(*s, dtype=torch.bfloat16) * 0.4)(Hq * Dh, D) * ((Hq * Dh) ** -0.5)),
        }
    _A_in = _A_setup()

    def _B_setup():
        B, S, D, F = 8, 1, 512, 1792
        return {
            "x": _w((lambda *s: torch.randn(*s, dtype=torch.bfloat16) * 0.05)(B, S, D)),
            "w1": _w((lambda *s: torch.randn(*s, dtype=torch.bfloat16) * 3.2)(D, F) * (D ** -0.5)),
            "b1": _w((lambda *s: torch.randn(*s, dtype=torch.bfloat16) * 1.6)(F)),
            "w2": _w((lambda *s: torch.randn(*s, dtype=torch.bfloat16) * 0.2)(F, D) * (F ** -0.5)),
            "b2": _w((lambda *s: torch.randn(*s, dtype=torch.bfloat16) * 0.4)(D)),
        }
    _B_in = _B_setup()

    return {
        "A_x": _A_in["x"],
        "A_k_cache": _A_in["k_cache"],
        "A_v_cache": _A_in["v_cache"],
        "A_wq": _A_in["wq"],
        "A_wo": _A_in["wo"],
        "B_x": _B_in["x"],
        "B_w1": _B_in["w1"],
        "B_b1": _B_in["b1"],
        "B_w2": _B_in["w2"],
        "B_b2": _B_in["b2"],
    }

def reference(A_x, A_k_cache, A_v_cache, A_wq, A_wo, B_x, B_w1, B_b1, B_w2, B_b2):
    def _A_ref(x, k_cache, v_cache, wq, wo):
        B, Sq, D = x.shape
        Hq, Dh = 32, 128
        Hkv, Sk = k_cache.shape[1], k_cache.shape[2]
        W = min(4096, max(256, Sk // 4))
        rep = Hq // Hkv
        q = (lambda x, *d: x.permute(*d))((x @ wq).reshape(B, Sq, Hq, Dh), 0, 2, 1, 3)
        k = (lambda x, n, axis: torch.repeat_interleave(x, n, dim=axis))(k_cache[:, :, Sk - W:, :], rep, axis=1)
        v = (lambda x, n, axis: torch.repeat_interleave(x, n, dim=axis))(v_cache[:, :, Sk - W:, :], rep, axis=1)
        scores = torch.einsum("bhqd,bhkd->bhqk", q, k) * (Dh ** -0.5)
        p = _softmax(scores, axis=-1)
        o = torch.einsum("bhqk,bhkd->bhqd", p, v)
        return (lambda x, *d: x.permute(*d))(o, 0, 2, 1, 3).reshape(B, Sq, Hq * Dh) @ wo

    def _B_ref(x, w1, b1, w2, b2):
        y = _layernorm(x, axis=-1)
        h = _gelu(torch.einsum("bsd,df->bsf", y, w1) + b1)
        return torch.einsum("bsf,fd->bsd", h, w2) + b2

    x = A_x
    h = x + _A_ref(_layernorm(x, axis=-1), A_k_cache, A_v_cache, A_wq, A_wo)
    h2 = h + _B_ref(_layernorm(h, axis=-1), B_w1, B_b1, B_w2, B_b2)
    return h2
```

```asm
; @launch grid=(256,1,1) block=(768,1,1) lds=159232
.amdgcn_target "amdgcn-amd-amdhsa--gfx950"
.text
.globl sequential_preLN__sliding_block_cached__mixer_channel_mlp__decode_kernel
.p2align 8
.type sequential_preLN__sliding_block_cached__mixer_channel_mlp__decode_kernel,@function
sequential_preLN__sliding_block_cached__mixer_channel_mlp__decode_kernel:
    s_cmp_ge_u32 s2, 256
    s_cbranch_scc1 L_end
    s_getpc_b64 s[44:45]
    s_and_b32 s44, s44, 0xffffff00
    s_lshr_b32 s5, s2, 3
    s_mul_i32 s4, s5, 12288
    v_lshl_add_u32 v1, v0, 4, s4
    v_cmp_gt_u32 vcc, 13292, v1
    s_and_saveexec_b64 s[46:47], vcc
    s_cbranch_execz L_nocpf
    global_load_dwordx4 v[132:135], v1, s[44:45]
L_nocpf:
    s_mov_b64 exec, -1
    s_load_dwordx16 s[16:31], s[0:1], 0
    s_load_dwordx8 s[32:39], s[0:1], 64
    s_load_dwordx2 s[40:41], s[0:1], 96
    v_lshrrev_b32 v1, 6, v0
    v_and_b32 v2, 63, v0
    v_readfirstlane_b32 s3, v1
    s_and_b32 s4, s2, 7
    s_lshr_b32 s5, s2, 3
    s_lshr_b32 s6, s5, 2
    s_and_b32 s7, s5, 3
    v_lshrrev_b32 v5, 3, v2
    v_and_b32 v6, 7, v2
    v_lshlrev_b32 v6, 4, v6
    v_lshrrev_b32 v3, 4, v2
    v_and_b32 v4, 15, v2
    s_mov_b32 s15, 0
    s_mov_b32 s60, 0
    v_mov_b32 v1, 159168
    s_cmp_ge_u32 s3, 8
    s_cbranch_scc1 L_loader
    v_lshlrev_b32 v24, 4, v0
    v_lshl_add_u32 v25, v5, 13, v6
    s_lshl_b32 s12, s7, 20
    s_lshl_b32 s13, s3, 17
    s_add_u32 s12, s12, s13
    s_lshl_b32 s13, s4, 10
    s_add_u32 s12, s12, s13
    s_lshl_b32 s13, s6, 7
    s_add_u32 s12, s12, s13
    s_lshl_b32 s13, s3, 11
    s_add_u32 s13, s13, 131072
    s_mov_b32 m0, s13
    s_mov_b32 s54, 0x400000
    s_mov_b32 s55, 0x20000
    v_mov_b32 v32, 0
    v_mov_b32 v33, 0
    v_mov_b32 v34, 0
    v_mov_b32 v35, 0
    ds_write_b128 v1, v[32:35]
    ds_write_b128 v1, v[32:35] offset:16
    ds_write_b128 v1, v[32:35] offset:32
    s_waitcnt lgkmcnt(0)
    s_mov_b32 s52, s22
    s_mov_b32 s53, s23
    global_load_dwordx4 v[52:55], v24, s[16:17]
    buffer_load_dwordx4 v25, s[52:55], s12 offen nt lds
    s_add_u32 s13, s13, 1024
    s_mov_b32 m0, s13
    s_add_u32 s12, s12, 65536
    s_load_dwordx2 s[42:43], s[40:41], 0
    buffer_load_dwordx4 v25, s[52:55], s12 offen nt lds
    s_barrier
    s_mov_b32 s8, 1
    s_mov_b32 s9, s5
    s_cmp_lt_u32 s5, 16
    s_cbranch_scc1 L_role_1
    s_mov_b32 s8, 2
    s_and_b32 s9, s5, 7
    s_cmp_lt_u32 s5, 24
    s_cbranch_scc1 L_role_1
    s_mov_b32 s8, 3
    s_cmp_lt_u32 s9, 4
    s_cbranch_scc1 L_role_1
    s_mov_b32 s8, 4
    s_cmp_lt_u32 s9, 6
    s_cbranch_scc1 L_role_1
    s_mov_b32 s8, 0
L_role_1:
    s_mov_b32 s56, s40
    s_mov_b32 s57, s41
    s_mov_b32 s58, 0x400000
    s_mov_b32 s59, 0x20000
    v_mov_b32 v32, -1
    v_mov_b32 v33, -1
    v_mov_b32 v34, -1
    v_mov_b32 v35, -1
    v_lshlrev_b32 v27, 4, v2
L_clr_3:
    s_cmp_eq_u32 s3, 4
    s_cbranch_scc0 L_clr_4
    s_lshl_b32 s12, s4, 5
    s_add_u32 s12, s12, s5
    s_lshl_b32 s12, s12, 10
    s_add_u32 s12, s12, 1114112
    buffer_store_dwordx4 v[32:35], v27, s[56:59], s12 offen sc1
L_clr_4:
    s_lshl_b32 s61, s4, 5
    s_add_u32 s61, s61, s5
    s_lshl_b32 s61, s61, 7
    s_add_u32 s61, s61, 1376256
    s_cmp_eq_u32 s3, 7
    s_cbranch_scc0 L_clr_5
    s_mov_b64 exec, 0xff
    buffer_store_dwordx4 v[32:35], v27, s[56:59], s61 offen sc1
    s_mov_b64 exec, -1
L_clr_5:
    v_lshlrev_b32 v68, 14, v4
    v_lshl_add_u32 v68, v3, 4, v68
    s_lshl_b32 s11, s4, 17
    s_lshl_b32 s13, s7, 12
    s_add_u32 s11, s11, s13
    s_lshl_b32 s13, s6, 9
    s_add_u32 s11, s11, s13
    s_lshl_b32 s13, s3, 7
    s_add_u32 s11, s11, s13
    s_add_u32 s11, s11, 65536
    s_cmp_lt_u32 s3, 4
    s_cbranch_scc0 L_clr_6
    s_waitcnt lgkmcnt(0)
    v_mov_b32 v72, s42
    v_mov_b32 v73, s42
    v_mov_b32 v74, s42
    v_mov_b32 v75, s42
    s_mov_b32 exec_lo, 0x00ff00ff
    s_mov_b32 exec_hi, 0x00ff00ff
    buffer_store_dwordx4 v[72:75], v68, s[56:59], s11 offen
    buffer_store_dwordx4 v[72:75], v68, s[56:59], s11 offen offset:64
    s_mov_b64 exec, -1
L_clr_6:
    s_cmp_eq_u32 s8, 0
    s_cbranch_scc0 L_nopr
    s_waitcnt lgkmcnt(0)
    v_mov_b32 v60, s42
    v_mov_b32 v61, s42
    v_mov_b32 v62, s42
    v_mov_b32 v63, s42
    v_lshlrev_b32 v59, 13, v3
    v_lshl_add_u32 v59, v4, 4, v59
    s_lshl_b32 s38, s4, 18
    s_lshl_b32 s13, s3, 8
    s_add_u32 s38, s38, s13
    s_add_u32 s38, s38, 2342912
    s_mov_b32 exec_hi, 0
    buffer_store_dwordx4 v[60:63], v59, s[56:59], s38 offen sc1
    s_mov_b64 exec, -1
    s_add_u32 s38, s40, s38
    s_addc_u32 s39, s41, 0
L_nopr:
    v_mov_b32 v31, 1
    v_lshl_add_u32 v26, v5, 10, v6
    v_lshrrev_b32 v8, 2, v4
    v_and_b32 v9, 3, v4
    v_lshl_add_u32 v20, v3, 3, v8
    v_lshlrev_b32 v20, 7, v20
    v_lshl_add_u32 v20, v9, 3, v20
    s_lshl_b32 s10, s3, 13
    s_mul_i32 s14, s3, 1040
    v_add_u32 v23, s14, v27
    v_add_u32 v23, 147456, v23
    s_waitcnt vmcnt(2)
    v_lshlrev_b32 v36, 16, v52
    v_and_b32 v37, 0xffff0000, v52
    v_lshlrev_b32 v38, 16, v53
    v_and_b32 v39, 0xffff0000, v53
    v_lshlrev_b32 v40, 16, v54
    v_and_b32 v41, 0xffff0000, v54
    v_lshlrev_b32 v42, 16, v55
    v_and_b32 v43, 0xffff0000, v55
    v_readfirstlane_b32 s26, v36
    s_nop 1
    v_subrev_f32 v44, s26, v36
    v_subrev_f32 v45, s26, v37
    v_subrev_f32 v46, s26, v38
    v_subrev_f32 v47, s26, v39
    v_subrev_f32 v48, s26, v40
    v_subrev_f32 v49, s26, v41
    v_subrev_f32 v50, s26, v42
    v_subrev_f32 v51, s26, v43
    v_mul_f32 v52, v44, v44
    v_mul_f32 v53, v45, v45
    v_fmac_f32 v52, v46, v46
    v_fmac_f32 v53, v47, v47
    v_fmac_f32 v52, v48, v48
    v_fmac_f32 v53, v49, v49
    v_fmac_f32 v52, v50, v50
    v_fmac_f32 v53, v51, v51
    v_pk_add_f32 v[44:45], v[44:45], v[46:47]
    v_pk_add_f32 v[48:49], v[48:49], v[50:51]
    v_add_f32 v52, v52, v53
    v_pk_add_f32 v[44:45], v[44:45], v[48:49]
    v_add_f32 v44, v44, v45
    s_nop 0
    s_nop 0
    v_add_f32_dpp v44, v44, v44 quad_perm:[1,0,3,2] row_mask:0xf bank_mask:0xf
    v_add_f32_dpp v52, v52, v52 quad_perm:[1,0,3,2] row_mask:0xf bank_mask:0xf
    s_nop 0
    v_add_f32_dpp v44, v44, v44 quad_perm:[2,3,0,1] row_mask:0xf bank_mask:0xf
    v_add_f32_dpp v52, v52, v52 quad_perm:[2,3,0,1] row_mask:0xf bank_mask:0xf
    s_nop 0
    v_add_f32_dpp v44, v44, v44 row_half_mirror row_mask:0xf bank_mask:0xf
    v_add_f32_dpp v52, v52, v52 row_half_mirror row_mask:0xf bank_mask:0xf
    s_nop 0
    v_add_f32_dpp v44, v44, v44 row_mirror row_mask:0xf bank_mask:0xf
    v_add_f32_dpp v52, v52, v52 row_mirror row_mask:0xf bank_mask:0xf
    s_nop 0
    v_add_f32_dpp v44, v44, v44 row_bcast:15 row_mask:0xa bank_mask:0xf
    v_add_f32_dpp v52, v52, v52 row_bcast:15 row_mask:0xa bank_mask:0xf
    s_nop 0
    v_add_f32_dpp v44, v44, v44 row_bcast:31 row_mask:0xc bank_mask:0xf
    v_add_f32_dpp v52, v52, v52 row_bcast:31 row_mask:0xc bank_mask:0xf
    s_nop 0
    v_readlane_b32 s62, v44, 63
    v_readlane_b32 s63, v52, 63
    s_nop 1
    v_mov_b32 v44, 0x3b000000
    v_mul_f32 v45, s62, v44
    v_mul_f32 v46, s63, v44
    v_fma_f32 v46, -v45, v45, v46
    v_max_f32 v46, 0, v46
    v_add_f32 v45, s26, v45
    v_cvt_pk_bf16_f32 v47, v45, v46
    v_and_b32 v46, 0xffff0000, v47
    v_add_f32 v46, 0x3727c5ac, v46
    v_lshlrev_b32 v44, 16, v47
    v_cvt_pk_bf16_f32 v46, v46, v46
    v_and_b32 v46, 0xffff0000, v46
    v_sqrt_f32 v46, v46
    v_mov_b32 v45, v44
    v_cvt_pk_bf16_f32 v46, v46, v46
    v_and_b32 v46, 0xffff0000, v46
    v_rcp_f32 v46, v46
    v_pk_add_f32 v[36:37], v[36:37], v[44:45] neg_lo:[0,1] neg_hi:[0,1]
    v_pk_add_f32 v[38:39], v[38:39], v[44:45] neg_lo:[0,1] neg_hi:[0,1]
    v_pk_add_f32 v[40:41], v[40:41], v[44:45] neg_lo:[0,1] neg_hi:[0,1]
    v_pk_add_f32 v[42:43], v[42:43], v[44:45] neg_lo:[0,1] neg_hi:[0,1]
    v_mov_b32 v47, v46
    v_cvt_pk_bf16_f32 v52, v36, v37
    v_cvt_pk_bf16_f32 v53, v38, v39
    v_cvt_pk_bf16_f32 v54, v40, v41
    v_cvt_pk_bf16_f32 v55, v42, v43
    v_lshlrev_b32 v36, 16, v52
    v_and_b32 v37, 0xffff0000, v52
    v_lshlrev_b32 v38, 16, v53
    v_and_b32 v39, 0xffff0000, v53
    v_lshlrev_b32 v40, 16, v54
    v_and_b32 v41, 0xffff0000, v54
    v_lshlrev_b32 v42, 16, v55
    v_and_b32 v43, 0xffff0000, v55
    v_pk_mul_f32 v[36:37], v[36:37], v[46:47]
    v_pk_mul_f32 v[38:39], v[38:39], v[46:47]
    v_pk_mul_f32 v[40:41], v[40:41], v[46:47]
    v_pk_mul_f32 v[42:43], v[42:43], v[46:47]
    v_cvt_pk_bf16_f32 v52, v36, v37
    v_cvt_pk_bf16_f32 v53, v38, v39
    v_cvt_pk_bf16_f32 v54, v40, v41
    v_cvt_pk_bf16_f32 v55, v42, v43
    ds_write_b128 v23, v[52:55]
    v_and_b32 v21, 7, v4
    v_mul_u32_u24 v21, 1040, v21
    v_lshl_add_u32 v21, v3, 4, v21
    s_lshl_b32 s14, s7, 8
    s_add_u32 s14, s14, 147456
    v_add_u32 v23, s14, v21
    s_lshl_b32 s14, s3, 5
    s_add_u32 s14, s14, 131072
    v_add_u32 v22, s14, v20
    v_mov_b32 v69, 0xffffff00
    s_waitcnt vmcnt(0) lgkmcnt(0)
    s_mov_b64 exec, 1
    ds_add_u32 v1, v31 offset:0
    s_mov_b64 exec, -1
    s_add_u32 s42, s42, 1
    s_addc_u32 s43, s43, 0
    s_and_b32 s62, s42, 0xff
    s_lshr_b64 s[26:27], s[42:43], 8
    s_getreg_b32 s18, hwreg(HW_REG_XCC_ID)
    s_and_b32 s18, s18, 7
    s_lshl_b32 s63, s26, 3
    s_or_b32 s63, s63, s18
    v_mov_b32 v73, s63
    v_mov_b32 v75, s63
    v_mov_b32 v77, s63
    v_mov_b32 v79, s63
L_sb_2:
    ds_read_b32 v30, v1 offset:0
    s_waitcnt lgkmcnt(0)
    v_cmp_gt_u32 vcc, 8, v30
    s_nop 0
    s_cbranch_vccz L_sb_2d
    s_add_u32 s15, s15, 1
    s_cmp_gt_u32 s15, 100000
    s_cbranch_scc1 L_sb_2d
    s_branch L_sb_2
L_sb_2d:
    s_cmp_lt_u32 s3, 4
    s_cbranch_scc1 L_qmm
    v_mov_b32 v32, -1
    v_mov_b32 v33, -1
    v_mov_b32 v34, -1
    v_mov_b32 v35, -1
    s_lshl_b32 s12, s4, 5
    s_add_u32 s12, s12, s5
    s_lshl_b32 s12, s12, 10
    s_add_u32 s12, s12, 1114112
    s_cmp_eq_u32 s3, 4
    s_cbranch_scc1 L_pw_go
    s_mov_b32 s12, s61
    s_mov_b64 exec, 0xff
    s_cmp_eq_u32 s3, 7
    s_cbranch_scc1 L_pw_go
    s_mov_b64 exec, -1
    s_branch L_qdone
L_pw_go:
    buffer_store_dwordx4 v[32:35], v27, s[56:59], s12 offen
    s_mov_b64 exec, -1
    s_branch L_qdone
L_qmm:
    ds_read_b64_tr_b16 v[32:33], v22 offset:0
    ds_read_b64_tr_b16 v[34:35], v22 offset:512
    ds_read_b128 v[36:39], v23 offset:0
    ds_read_b64_tr_b16 v[40:41], v22 offset:4096
    ds_read_b64_tr_b16 v[42:43], v22 offset:4608
    ds_read_b128 v[44:47], v23 offset:64
    ds_read_b64_tr_b16 v[48:49], v22 offset:8192
    ds_read_b64_tr_b16 v[50:51], v22 offset:8704
    ds_read_b128 v[52:55], v23 offset:128
    ds_read_b64_tr_b16 v[56:57], v22 offset:12288
    ds_read_b64_tr_b16 v[58:59], v22 offset:12800
    ds_read_b128 v[60:63], v23 offset:192
    s_waitcnt lgkmcnt(9)
    v_mfma_f32_16x16x32_bf16 v[64:67], v[32:35], v[36:39], 0
    s_waitcnt lgkmcnt(6)
    v_mfma_f32_16x16x32_bf16 v[64:67], v[40:43], v[44:47], v[64:67]
    s_waitcnt lgkmcnt(3)
    v_mfma_f32_16x16x32_bf16 v[64:67], v[48:51], v[52:55], v[64:67]
    s_waitcnt lgkmcnt(0)
    v_mfma_f32_16x16x32_bf16 v[64:67], v[56:59], v[60:63], v[64:67]
    s_nop 7
    v_add_u32 v64, 0x80, v64
    v_add_u32 v65, 0x80, v65
    v_add_u32 v66, 0x80, v66
    v_add_u32 v67, 0x80, v67
    v_bfi_b32 v72, v69, v64, s62
    v_bfi_b32 v74, v69, v65, s62
    v_bfi_b32 v76, v69, v66, s62
    v_bfi_b32 v78, v69, v67, s62
    s_mov_b32 exec_lo, 0xff00ff
    s_mov_b32 exec_hi, 0xff00ff
    buffer_store_dwordx4 v[72:75], v68, s[56:59], s11 offen
    buffer_store_dwordx4 v[76:79], v68, s[56:59], s11 offen offset:64
    s_mov_b64 exec, -1
    s_mov_b32 s60, 8
L_qdone:
    v_lshlrev_b32 v22, 3, v0
    s_lshl_b32 s27, s4, 3
    s_add_u32 s27, s27, s6
    s_lshl_b32 s27, s27, 14
    s_add_u32 s27, s27, 65536
    s_lshr_b32 s14, s3, 1
    s_mul_i32 s14, s14, 272
    s_and_b32 s13, s3, 1
    s_lshl_b32 s13, s13, 7
    s_add_u32 s14, s14, s13
    s_add_u32 s14, s14, 155776
    v_and_b32 v23, 6, v4
    v_lshlrev_b32 v23, 1, v23
    v_lshrrev_b32 v28, 3, v4
    v_lshl_add_u32 v23, v28, 1, v23
    v_and_b32 v28, 1, v4
    v_add_u32 v23, v23, v28
    v_lshl_add_u32 v23, v3, 4, v23
    v_lshl_add_u32 v23, v23, 1, s14
    v_xor_b32 v28, v4, v3
    v_lshlrev_b32 v29, 8, v4
    v_add_u32 v29, s10, v29
    v_xor_b32 v30, 0, v28
    v_lshl_add_u32 v16, v30, 4, v29
    v_xor_b32 v30, 4, v28
    v_lshl_add_u32 v17, v30, 4, v29
    v_xor_b32 v30, 8, v28
    v_lshl_add_u32 v18, v30, 4, v29
    v_xor_b32 v30, 12, v28
    v_lshl_add_u32 v19, v30, 4, v29
    v_and_b32 v7, 3, v4
    v_mul_u32_u24 v25, 272, v7
    v_lshl_add_u32 v25, v3, 4, v25
    v_add_u32 v25, 155776, v25
    v_lshlrev_b32 v92, 5, v7
    s_lshl_b32 s14, s3, 2
    v_add_u32 v93, s14, v92
    v_add_u32 v92, 158912, v92
    v_add_u32 v93, 158912, v93
    v_lshl_add_u32 v94, v3, 2, v7
    v_lshlrev_b32 v94, 4, v94
    v_add_u32 v94, 156864, v94
    s_lshl_b32 s14, s3, 8
    v_add_u32 v95, s14, v94
    v_lshl_add_u32 v96, v3, 2, v8
    v_and_b32 v97, 7, v96
    v_lshlrev_b32 v97, 1, v97
    v_lshrrev_b32 v98, 1, v9
    s_lshl_b32 s14, s3, 1
    v_add_u32 v98, s14, v98
    v_xor_b32 v97, v97, v98
    v_lshlrev_b32 v96, 8, v96
    v_lshl_add_u32 v96, v97, 4, v96
    v_and_b32 v97, 1, v9
    v_lshl_add_u32 v96, v97, 3, v96
    v_add_u32 v96, 65536, v96
    v_lshlrev_b32 v142, 8, v7
    v_lshl_add_u32 v142, v3, 3, v142
    v_mov_b32 v88, 0x3db504f3
    v_mov_b32 v89, 0x3db504f3
    s_mov_b32 s23, 0
    s_cmp_eq_u32 s8, 0
    s_cbranch_scc0 L_pb_3
    s_and_b32 s13, s5, 1
    s_lshl_b32 s13, s13, 7
    s_and_b32 s14, s3, 1
    s_lshl_b32 s45, s14, 13
    s_add_u32 s13, s13, s45
    s_xor_b32 s12, s13, 8192
    s_memtime s[46:47]
    s_waitcnt lgkmcnt(0)
    s_load_dword s45, s[38:39], s13
    s_waitcnt lgkmcnt(0)
    s_memtime s[48:49]
    s_waitcnt lgkmcnt(0)
    s_load_dword s45, s[38:39], s12
    s_waitcnt lgkmcnt(0)
    s_memtime s[50:51]
    s_waitcnt lgkmcnt(0)
    s_sub_u32 s46, s48, s46
    s_sub_u32 s48, s50, s48
    s_cmp_lt_u32 s46, s48
    s_cselect_b32 s46, 1, 0
    s_cmp_lg_u32 s46, s14
    s_cbranch_scc0 L_pb_3
    s_mov_b64 exec, 1
    ds_add_u32 v1, v31 offset:32
    s_mov_b64 exec, -1
L_pb_3:
    s_cmp_eq_u32 s8, 0
    s_cbranch_scc1 L_q_poll
    s_sleep 20
    s_branch L_q_poll
L_q_retry:
    s_cmp_eq_u32 s23, 1
    s_cbranch_scc1 L_q_poll
    ds_read_b32 v30, v1 offset:28
    s_waitcnt lgkmcnt(0)
    v_cmp_gt_u32 vcc, 4, v30
    s_nop 0
    s_cbranch_vccnz L_q_poll
    ds_read_b128 v[48:51], v16 offset:0
    ds_read_b128 v[52:55], v17 offset:0
    ds_read_b128 v[56:59], v18 offset:0
    ds_read_b128 v[60:63], v19 offset:0
    ds_read_b128 v[100:103], v16 offset:4096
    ds_read_b128 v[104:107], v17 offset:4096
    ds_read_b128 v[108:111], v18 offset:4096
    ds_read_b128 v[112:115], v19 offset:4096
    s_waitcnt lgkmcnt(0)
    s_mov_b64 exec, 1
    ds_add_u32 v1, v31 offset:8
    s_mov_b64 exec, -1
    s_mov_b32 s23, 1
L_q_poll:
    s_mov_b32 s14, s27
    buffer_load_dwordx2 v[120:121], v22, s[56:59], s14 offen sc1
    s_add_u32 s14, s14, 4096
    buffer_load_dwordx2 v[122:123], v22, s[56:59], s14 offen sc1
    s_add_u32 s14, s14, 4096
    buffer_load_dwordx2 v[124:125], v22, s[56:59], s14 offen sc1
    s_add_u32 s14, s14, 4096
    buffer_load_dwordx2 v[126:127], v22, s[56:59], s14 offen sc1
    s_waitcnt vmcnt(0)
    v_xor_b32 v32, v120, v122
    v_xor_b32 v33, v124, v126
    v_xor_b32 v34, s62, v120
    v_xor_b32 v35, s62, v124
    v_or3_b32 v32, v32, v33, v34
    v_or_b32 v32, v32, v35
    v_and_b32 v32, 0xff, v32
    v_xor_b32 v33, s63, v121
    v_xor_b32 v34, s63, v123
    v_xor_b32 v35, s63, v125
    v_xor_b32 v36, s63, v127
    v_or3_b32 v33, v33, v34, v35
    v_or_b32 v33, v33, v36
    v_lshrrev_b32 v34, 3, v33
    v_or_b32 v32, v32, v34
    v_cmp_ne_u32 vcc, 0, v32
    v_and_b32 v120, 0xffffff00, v120
    v_and_b32 v122, 0xffffff00, v122
    s_cbranch_vccz L_q_got
    s_add_u32 s15, s15, 1
    s_cmp_gt_u32 s15, 100000
    s_cbranch_scc1 L_q_got
    s_sleep 4
    s_cmp_eq_u32 s60, 0
    s_cbranch_scc1 L_q_retry
    s_sub_u32 s60, s60, 1
    s_cmp_eq_u32 s60, 0
    s_cbranch_scc0 L_q_retry
    s_mov_b32 exec_lo, 0xff00ff
    s_mov_b32 exec_hi, 0xff00ff
    buffer_store_dwordx4 v[72:75], v68, s[56:59], s11 offen sc1
    buffer_store_dwordx4 v[76:79], v68, s[56:59], s11 offen offset:64 sc1
    s_mov_b64 exec, -1
    s_waitcnt vmcnt(0)
    s_branch L_q_retry
L_q_got:
    v_and_b32 v124, 0xffffff00, v124
    v_and_b32 v126, 0xffffff00, v126
    v_add_f32 v120, v120, v122
    v_add_f32 v124, v124, v126
    v_add_f32 v120, v120, v124
    v_cvt_pk_bf16_f32 v120, v120, v120
    ds_write_b16 v23, v120
    v_cmp_ne_u32 vcc, 0, v33
    s_mov_b64 exec, 1
    s_cbranch_vccnz L_noloc
    ds_add_u32 v1, v31 offset:20
L_noloc:
    s_mov_b64 exec, 1
    ds_add_u32 v1, v31 offset:4
    s_mov_b64 exec, -1
    s_cmp_eq_u32 s23, 1
    s_cbranch_scc1 L_kdone
L_sb_4:
    ds_read_b32 v30, v1 offset:28
    s_waitcnt lgkmcnt(0)
    v_cmp_gt_u32 vcc, 4, v30
    s_nop 0
    s_cbranch_vccz L_sb_4d
    s_add_u32 s15, s15, 1
    s_cmp_gt_u32 s15, 100000
    s_cbranch_scc1 L_sb_4d
    s_branch L_sb_4
L_sb_4d:
    ds_read_b128 v[48:51], v16 offset:0
    ds_read_b128 v[52:55], v17 offset:0
    ds_read_b128 v[56:59], v18 offset:0
    ds_read_b128 v[60:63], v19 offset:0
    ds_read_b128 v[100:103], v16 offset:4096
    ds_read_b128 v[104:107], v17 offset:4096
    ds_read_b128 v[108:111], v18 offset:4096
    ds_read_b128 v[112:115], v19 offset:4096
    s_waitcnt lgkmcnt(0)
    s_mov_b64 exec, 1
    ds_add_u32 v1, v31 offset:8
    s_mov_b64 exec, -1
    s_mov_b32 s23, 1
L_kdone:
    s_cmp_eq_u32 s60, 0
    s_cselect_b32 s60, 0, 64
L_sb_5:
    ds_read_b32 v30, v1 offset:4
    s_waitcnt lgkmcnt(0)
    v_cmp_gt_u32 vcc, 8, v30
    s_nop 0
    s_cbranch_vccz L_sb_5d
    s_add_u32 s15, s15, 1
    s_cmp_gt_u32 s15, 100000
    s_cbranch_scc1 L_sb_5d
    s_cmp_eq_u32 s60, 0
    s_cbranch_scc1 L_sb_5
    s_sub_u32 s60, s60, 1
    s_cmp_eq_u32 s60, 0
    s_cbranch_scc0 L_sb_5
    s_mov_b32 exec_lo, 0xff00ff
    s_mov_b32 exec_hi, 0xff00ff
    buffer_store_dwordx4 v[72:75], v68, s[56:59], s11 offen sc1
    buffer_store_dwordx4 v[76:79], v68, s[56:59], s11 offen offset:64 sc1
    s_mov_b64 exec, -1
    s_waitcnt vmcnt(0)
    s_branch L_sb_5
L_sb_5d:
    s_lshl_b32 s44, s43, 1
    s_xor_b32 s13, s3, 7
    s_or_b32 s13, s8, s13
    s_cmp_eq_u32 s13, 0
    s_cbranch_scc0 L_novp
    ds_read_b32 v30, v1 offset:32
    v_lshlrev_b32 v28, 7, v2
    s_and_b32 s13, s5, 1
    s_lshl_b32 s13, s13, 3
    s_add_u32 s13, s13, s4
    s_lshl_b32 s13, s13, 3
    s_add_u32 s13, s13, 8192
    v_mov_b32 v116, s42
    s_waitcnt lgkmcnt(0)
    v_cmp_gt_u32 vcc, 4, v30
    v_mov_b32 v117, s44
    s_nop 0
    v_addc_co_u32 v117, vcc, 0, v117, vcc
    s_mov_b64 exec, 0xff
    buffer_store_dwordx2 v[116:117], v28, s[56:59], s13 offen sc1
    s_mov_b64 exec, -1
L_novp:
    ds_read_b32 v30, v1 offset:20
    ds_read_b128 v[32:35], v25 offset:0
    ds_read_b128 v[36:39], v25 offset:64
    ds_read_b128 v[40:43], v25 offset:128
    ds_read_b128 v[44:47], v25 offset:192
    s_waitcnt lgkmcnt(3)
    v_mfma_f32_16x16x32_bf16 v[80:83], v[48:51], v[32:35], 0
    v_mfma_f32_16x16x32_bf16 v[84:87], v[100:103], v[32:35], 0
    s_waitcnt lgkmcnt(2)
    v_mfma_f32_16x16x32_bf16 v[80:83], v[52:55], v[36:39], v[80:83]
    v_mfma_f32_16x16x32_bf16 v[84:87], v[104:107], v[36:39], v[84:87]
    s_waitcnt lgkmcnt(1)
    v_mfma_f32_16x16x32_bf16 v[80:83], v[56:59], v[40:43], v[80:83]
    v_mfma_f32_16x16x32_bf16 v[84:87], v[108:111], v[40:43], v[84:87]
    s_waitcnt lgkmcnt(0)
    v_mfma_f32_16x16x32_bf16 v[80:83], v[60:63], v[44:47], v[80:83]
    v_mfma_f32_16x16x32_bf16 v[84:87], v[112:115], v[44:47], v[84:87]
    v_readfirstlane_b32 s19, v30
    s_nop 3
    s_cmp_eq_u32 s19, 8
    s_cselect_b32 s60, 0, s60
    v_cvt_pk_bf16_f32 v90, v80, v81
    v_lshlrev_b32 v80, 16, v90
    v_and_b32 v81, 0xffff0000, v90
    v_pk_mul_f32 v[80:81], v[80:81], v[88:89]
    v_cvt_pk_bf16_f32 v90, v80, v81
    v_lshlrev_b32 v80, 16, v90
    v_and_b32 v81, 0xffff0000, v90
    v_cvt_pk_bf16_f32 v90, v82, v83
    v_lshlrev_b32 v82, 16, v90
    v_and_b32 v83, 0xffff0000, v90
    v_pk_mul_f32 v[82:83], v[82:83], v[88:89]
    v_cvt_pk_bf16_f32 v90, v82, v83
    v_lshlrev_b32 v82, 16, v90
    v_and_b32 v83, 0xffff0000, v90
    v_cvt_pk_bf16_f32 v90, v84, v85
    v_lshlrev_b32 v84, 16, v90
    v_and_b32 v85, 0xffff0000, v90
    v_pk_mul_f32 v[84:85], v[84:85], v[88:89]
    v_cvt_pk_bf16_f32 v90, v84, v85
    v_lshlrev_b32 v84, 16, v90
    v_and_b32 v85, 0xffff0000, v90
    v_cvt_pk_bf16_f32 v90, v86, v87
    v_lshlrev_b32 v86, 16, v90
    v_and_b32 v87, 0xffff0000, v90
    v_pk_mul_f32 v[86:87], v[86:87], v[88:89]
    v_cvt_pk_bf16_f32 v90, v86, v87
    v_lshlrev_b32 v86, 16, v90
    v_and_b32 v87, 0xffff0000, v90
    v_max3_f32 v90, v80, v81, v82
    v_max3_f32 v91, v83, v84, v85
    v_max3_f32 v90, v90, v86, v87
    v_max_f32 v90, v90, v91
    v_mov_b32 v91, v90
    s_nop 1
    v_permlane16_swap_b32 v90, v91
    v_max_f32 v90, v90, v91
    v_mov_b32 v91, v90
    s_nop 1
    v_permlane32_swap_b32 v90, v91
    v_max_f32 v90, v90, v91
    v_mov_b32 v88, 0x3fb8aa3b
    v_mov_b32 v89, 0x3fb8aa3b
    v_mov_b32 v91, v90
    ds_write_b32 v93, v90
    v_pk_add_f32 v[80:81], v[80:81], v[90:91] neg_lo:[0,1] neg_hi:[0,1]
    v_pk_add_f32 v[82:83], v[82:83], v[90:91] neg_lo:[0,1] neg_hi:[0,1]
    v_pk_add_f32 v[84:85], v[84:85], v[90:91] neg_lo:[0,1] neg_hi:[0,1]
    v_pk_add_f32 v[86:87], v[86:87], v[90:91] neg_lo:[0,1] neg_hi:[0,1]
    v_pk_mul_f32 v[80:81], v[80:81], v[88:89]
    v_pk_mul_f32 v[82:83], v[82:83], v[88:89]
    v_pk_mul_f32 v[84:85], v[84:85], v[88:89]
    v_pk_mul_f32 v[86:87], v[86:87], v[88:89]
    v_exp_f32 v80, v80
    v_exp_f32 v81, v81
    v_exp_f32 v82, v82
    v_exp_f32 v83, v83
    v_exp_f32 v84, v84
    v_exp_f32 v85, v85
    v_exp_f32 v86, v86
    v_exp_f32 v87, v87
    s_nop 0
    v_cvt_pk_bf16_f32 v32, v80, v81
    v_cvt_pk_bf16_f32 v33, v82, v83
    v_cvt_pk_bf16_f32 v34, v84, v85
    v_cvt_pk_bf16_f32 v35, v86, v87
    ds_write_b128 v95, v[32:35]
    v_pk_add_f32 v[80:81], v[80:81], v[82:83]
    v_pk_add_f32 v[84:85], v[84:85], v[86:87]
    v_pk_add_f32 v[80:81], v[80:81], v[84:85]
    v_add_f32 v80, v80, v81
    v_mov_b32 v81, v80
    s_nop 1
    v_permlane16_swap_b32 v80, v81
    v_add_f32 v80, v80, v81
    v_mov_b32 v81, v80
    s_nop 1
    v_permlane32_swap_b32 v80, v81
    v_add_f32 v80, v80, v81
    ds_write_b32 v93, v80 offset:128
    s_mov_b64 exec, 1
    ds_add_u32 v1, v31 offset:12
    s_mov_b64 exec, -1
    s_cmp_eq_u32 s60, 0
    s_cbranch_scc1 L_pf_6
    s_mov_b32 exec_lo, 0xff00ff
    s_mov_b32 exec_hi, 0xff00ff
    buffer_store_dwordx4 v[72:75], v68, s[56:59], s11 offen sc1
    buffer_store_dwordx4 v[76:79], v68, s[56:59], s11 offen offset:64 sc1
    s_mov_b64 exec, -1
    s_waitcnt vmcnt(0)
    s_mov_b32 s60, 0
L_pf_6:
L_sb_7:
    ds_read_b32 v30, v1 offset:12
    s_waitcnt lgkmcnt(0)
    v_cmp_gt_u32 vcc, 8, v30
    s_nop 0
    s_cbranch_vccz L_sb_7d
    s_add_u32 s15, s15, 1
    s_cmp_gt_u32 s15, 100000
    s_cbranch_scc1 L_sb_7d
    s_branch L_sb_7
L_sb_7d:
    ds_read_b128 v[80:83], v92
    ds_read_b128 v[84:87], v92 offset:16
    ds_read_b128 v[64:67], v92 offset:128
    ds_read_b128 v[68:71], v92 offset:144
    ds_read_b128 v[32:35], v94 offset:0
    ds_read_b128 v[36:39], v94 offset:256
    ds_read_b128 v[40:43], v94 offset:512
    ds_read_b128 v[44:47], v94 offset:768
    ds_read_b128 v[48:51], v94 offset:1024
    ds_read_b128 v[52:55], v94 offset:1280
    ds_read_b128 v[56:59], v94 offset:1536
    ds_read_b128 v[60:63], v94 offset:1792
    s_lshl_b32 s11, s4, 5
    s_add_u32 s11, s11, s5
    s_lshl_b32 s11, s11, 10
    s_lshl_b32 s13, s3, 5
    s_add_u32 s11, s11, s13
    s_add_u32 s11, s11, 1114112
    s_waitcnt lgkmcnt(0)
    v_max3_f32 v90, v80, v81, v82
    v_max3_f32 v91, v83, v84, v85
    v_max3_f32 v90, v90, v86, v87
    v_max_f32 v90, v90, v91
    v_mov_b32 v91, v90
    v_pk_add_f32 v[80:81], v[80:81], v[90:91] neg_lo:[0,1] neg_hi:[0,1]
    v_pk_add_f32 v[82:83], v[82:83], v[90:91] neg_lo:[0,1] neg_hi:[0,1]
    v_pk_add_f32 v[84:85], v[84:85], v[90:91] neg_lo:[0,1] neg_hi:[0,1]
    v_pk_add_f32 v[86:87], v[86:87], v[90:91] neg_lo:[0,1] neg_hi:[0,1]
    v_pk_mul_f32 v[80:81], v[80:81], v[88:89]
    v_pk_mul_f32 v[82:83], v[82:83], v[88:89]
    v_pk_mul_f32 v[84:85], v[84:85], v[88:89]
    v_pk_mul_f32 v[86:87], v[86:87], v[88:89]
    v_exp_f32 v80, v80
    v_exp_f32 v81, v81
    v_exp_f32 v82, v82
    v_exp_f32 v83, v83
    v_exp_f32 v84, v84
    v_exp_f32 v85, v85
    v_exp_f32 v86, v86
    v_exp_f32 v87, v87
    s_nop 0
    v_pk_mul_f32 v[64:65], v[64:65], v[80:81]
    v_pk_fma_f32 v[64:65], v[66:67], v[82:83], v[64:65]
    v_pk_fma_f32 v[64:65], v[68:69], v[84:85], v[64:65]
    v_pk_fma_f32 v[64:65], v[70:71], v[86:87], v[64:65]
    v_add_f32 v64, v64, v65
    v_rcp_f32 v66, v64
    v_log_f32 v68, v64
    s_cmp_eq_u32 s3, 7
    v_mul_f32 v144, v80, v66
    v_mul_f32 v145, v81, v66
    v_mul_f32 v146, v82, v66
    v_mul_f32 v147, v83, v66
    v_mul_f32 v148, v84, v66
    v_mul_f32 v149, v85, v66
    v_mul_f32 v150, v86, v66
    v_mul_f32 v151, v87, v66
    s_cbranch_scc0 L_nostat
    v_fmac_f32 v68, v88, v90
    v_min_u32 v68, -2, v68
    v_lshlrev_b32 v69, 2, v2
    s_mov_b32 exec_hi, 0
    buffer_store_dword v68, v69, s[56:59], s61 offen
    s_cmp_eq_u32 s19, 8
    s_cbranch_scc1 L_st_loc
    buffer_store_dword v68, v69, s[56:59], s61 offen sc1
L_st_loc:
    s_mov_b64 exec, -1
L_nostat:
    s_cmp_eq_u32 s8, 1
    s_cbranch_scc0 L_pre5
    s_lshr_b32 s20, s9, 2
    s_and_b32 s21, s9, 3
    v_mov_b32 v99, 0
    v_lshlrev_b32 v98, 2, v2
    s_lshl_b32 s12, s4, 5
    s_lshl_b32 s13, s3, 2
    s_add_u32 s12, s12, s13
    s_lshl_b32 s13, s12, 7
    s_lshl_b32 s14, s20, 2
    s_add_u32 s13, s13, s14
    s_add_u32 s13, s13, 1376256
    s_lshl_b32 s12, s12, 10
    s_lshl_b32 s14, s20, 8
    s_add_u32 s12, s12, s14
    s_add_u32 s12, s12, 1114112
    s_mul_i32 s14, s3, 272
    s_add_u32 s14, s14, 131072
    v_add_u32 v22, s14, v98
    v_and_b32 v23, 7, v4
    v_mul_u32_u24 v23, 272, v23
    v_lshl_add_u32 v23, v3, 4, v23
    v_add_u32 v23, 131072, v23
    v_lshrrev_b32 v10, 1, v9
    s_lshl_b32 s14, s3, 1
    v_add_u32 v10, s14, v10
    v_lshlrev_b32 v11, 1, v8
    v_xor_b32 v10, v10, v11
    v_lshl_add_u32 v11, v3, 3, v8
    v_lshlrev_b32 v11, 8, v11
    v_and_b32 v12, 1, v9
    v_lshl_add_u32 v11, v12, 3, v11
    v_xor_b32 v12, 8, v10
    v_lshl_add_u32 v10, v10, 4, v11
    v_lshl_add_u32 v11, v12, 4, v11
    v_add_u32 v11, 1024, v11
    v_lshrrev_b32 v25, 1, v3
    v_lshlrev_b32 v25, 10, v25
    v_and_b32 v12, 1, v3
    v_lshl_add_u32 v25, v12, 7, v25
    v_lshl_add_u32 v25, v4, 4, v25
    s_lshl_b32 s14, s4, 17
    s_lshl_b32 s26, s21, 14
    s_add_u32 s14, s14, s26
    s_lshl_b32 s26, s3, 11
    s_add_u32 s14, s14, s26
    s_lshl_b32 s26, s20, 8
    s_add_u32 s14, s14, s26
    s_add_u32 s14, s14, 65536
    s_and_b32 s21, s42, 0xfff
    s_xor_b32 s21, s21, 0x80
    v_mov_b32 v13, 0xfffff000
    s_and_b32 s45, s3, 3
    s_lshl_b32 s46, s5, 2
    s_add_u32 s45, s45, s46
    s_lshl_b32 s22, s45, 10
    s_lshl_b32 s46, s4, 17
    s_add_u32 s22, s22, s46
    s_add_u32 s22, s22, 65536
    s_and_b32 s46, s45, 7
    s_lshl_b32 s46, s46, 15
    s_lshr_b32 s45, s45, 3
    s_lshl_b32 s45, s45, 8
    s_add_u32 s46, s46, s45
    s_add_u32 s46, s46, 2097152
    s_lshr_b32 s45, s4, 2
    s_lshl_b32 s45, s45, 14
    s_add_u32 s23, s46, s45
    s_and_b32 s45, s4, 3
    s_lshl_b32 s45, s45, 11
    s_add_u32 s23, s23, s45
    s_xor_b32 s20, s21, 0x80
    s_branch L_pre5b
L_pre5:
    v_lshlrev_b32 v12, 3, v4
    s_lshl_b32 s38, s4, 7
    s_add_u32 s38, s38, 8192
L_pre5b:
    s_barrier
    ds_read_b64_tr_b16 v[100:101], v96 offset:0
    ds_read_b64_tr_b16 v[102:103], v96 offset:4096
    ds_read_b64_tr_b16 v[104:105], v96 offset:8192
    ds_read_b64_tr_b16 v[106:107], v96 offset:12288
    ds_read_b64_tr_b16 v[108:109], v96 offset:16384
    ds_read_b64_tr_b16 v[110:111], v96 offset:20480
    ds_read_b64_tr_b16 v[112:113], v96 offset:24576
    ds_read_b64_tr_b16 v[114:115], v96 offset:28672
    ds_read_b64_tr_b16 v[116:117], v96 offset:32768
    ds_read_b64_tr_b16 v[118:119], v96 offset:36864
    ds_read_b64_tr_b16 v[120:121], v96 offset:40960
    ds_read_b64_tr_b16 v[122:123], v96 offset:45056
    s_waitcnt lgkmcnt(10)
    v_mfma_f32_16x16x32_bf16 v[124:127], v[100:103], v[32:35], 0
    ds_read_b64_tr_b16 v[100:101], v96 offset:49152
    ds_read_b64_tr_b16 v[102:103], v96 offset:53248
    s_waitcnt lgkmcnt(10)
    v_mfma_f32_16x16x32_bf16 v[128:131], v[104:107], v[36:39], 0
    ds_read_b64_tr_b16 v[104:105], v96 offset:57344
    ds_read_b64_tr_b16 v[106:107], v96 offset:61440
    s_waitcnt lgkmcnt(10)
    v_mfma_f32_16x16x32_bf16 v[132:135], v[108:111], v[40:43], 0
    s_waitcnt lgkmcnt(8)
    v_mfma_f32_16x16x32_bf16 v[136:139], v[112:115], v[44:47], 0
    s_waitcnt lgkmcnt(6)
    v_mfma_f32_16x16x32_bf16 v[152:155], v[116:119], v[48:51], 0
    s_waitcnt lgkmcnt(4)
    v_mfma_f32_16x16x32_bf16 v[156:159], v[120:123], v[52:55], 0
    s_waitcnt lgkmcnt(2)
    v_mfma_f32_16x16x32_bf16 v[160:163], v[100:103], v[56:59], 0
    s_waitcnt lgkmcnt(0)
    v_mfma_f32_16x16x32_bf16 v[164:167], v[104:107], v[60:63], 0
    s_mov_b32 exec_lo, 0xf000f
    s_mov_b32 exec_hi, 0xf000f
    v_pk_mul_f32 v[72:73], v[124:125], v[144:145] op_sel_hi:[1,0]
    v_pk_mul_f32 v[74:75], v[126:127], v[144:145] op_sel_hi:[1,0]
    v_pk_fma_f32 v[72:73], v[128:129], v[144:145], v[72:73] op_sel:[0,1,0] op_sel_hi:[1,1,1]
    v_pk_fma_f32 v[74:75], v[130:131], v[144:145], v[74:75] op_sel:[0,1,0] op_sel_hi:[1,1,1]
    v_pk_fma_f32 v[72:73], v[132:133], v[146:147], v[72:73] op_sel_hi:[1,0,1]
    v_pk_fma_f32 v[74:75], v[134:135], v[146:147], v[74:75] op_sel_hi:[1,0,1]
    v_pk_fma_f32 v[72:73], v[136:137], v[146:147], v[72:73] op_sel:[0,1,0] op_sel_hi:[1,1,1]
    v_pk_fma_f32 v[74:75], v[138:139], v[146:147], v[74:75] op_sel:[0,1,0] op_sel_hi:[1,1,1]
    v_pk_fma_f32 v[72:73], v[152:153], v[148:149], v[72:73] op_sel_hi:[1,0,1]
    v_pk_fma_f32 v[74:75], v[154:155], v[148:149], v[74:75] op_sel_hi:[1,0,1]
    v_pk_fma_f32 v[72:73], v[156:157], v[148:149], v[72:73] op_sel:[0,1,0] op_sel_hi:[1,1,1]
    v_pk_fma_f32 v[74:75], v[158:159], v[148:149], v[74:75] op_sel:[0,1,0] op_sel_hi:[1,1,1]
    v_pk_fma_f32 v[72:73], v[160:161], v[150:151], v[72:73] op_sel_hi:[1,0,1]
    v_pk_fma_f32 v[74:75], v[162:163], v[150:151], v[74:75] op_sel_hi:[1,0,1]
    v_pk_fma_f32 v[72:73], v[164:165], v[150:151], v[72:73] op_sel:[0,1,0] op_sel_hi:[1,1,1]
    v_pk_fma_f32 v[74:75], v[166:167], v[150:151], v[74:75] op_sel:[0,1,0] op_sel_hi:[1,1,1]
    v_cvt_pk_bf16_f32 v76, v72, v73
    v_cvt_pk_bf16_f32 v77, v74, v75
    v_min_u32 v140, -2, v76
    v_min_u32 v141, -2, v77
    buffer_store_dwordx2 v[140:141], v142, s[56:59], s11 offen
    s_cmp_eq_u32 s19, 8
    s_cbranch_scc1 L_h1_loc
    buffer_store_dwordx2 v[140:141], v142, s[56:59], s11 offen sc1
L_h1_loc:
    s_mov_b64 exec, 1
    ds_add_u32 v1, v31 offset:24
    s_mov_b64 exec, -1
    s_cmp_eq_u32 s8, 1
    s_cbranch_scc1 L_B
    s_cmp_eq_u32 s8, 4
    s_cbranch_scc1 L_exit
L_gv_8:
    buffer_load_dwordx2 v[14:15], v12, s[56:59], s38 offen sc1
    s_waitcnt vmcnt(0)
L_gv_8c:
    v_xor_b32 v14, s42, v14
    v_xor_b32 v15, s44, v15
    v_lshrrev_b32 v36, 1, v15
    v_or_b32 v14, v14, v36
    v_cmp_ne_u32 vcc, 0, v14
    s_nop 0
    s_cbranch_vccz L_gv_8d
    s_add_u32 s15, s15, 1
    s_cmp_gt_u32 s15, 100000
    s_cbranch_scc1 L_gv_8d
    s_sleep 4
    s_branch L_gv_8
L_gv_8d:
    v_cmp_eq_u32 vcc, 1, v15
    s_nop 1
    s_xor_b32 s39, vcc_lo, 0xf0f0
    s_and_b32 s39, s39, 0xffff
    s_bcnt1_i32_b32 s39, s39
    s_cmp_lt_u32 s39, 8
    s_movk_i32 s39, 0xf0
    s_cselect_b32 s39, s39, 15
    s_cmp_eq_u32 s8, 2
    s_cbranch_scc1 L_R
    s_cmp_eq_u32 s8, 3
    s_cbranch_scc1 L_C
    s_cmp_eq_u32 s5, 31
    s_cbranch_scc0 L_exit
    v_lshl_add_u32 v28, v5, 10, v6
    s_xor_b32 s13, s4, 4
    s_lshr_b32 s14, s39, s13
    s_and_b32 s14, s14, 1
    s_xor_b32 s14, s14, 1
    s_lshl_b32 s14, s14, 13
    s_lshl_b32 s12, s13, 18
    s_add_u32 s12, s12, s14
    s_add_u32 s12, s12, 2097152
    s_lshl_b32 s13, s3, 7
    s_add_u32 s12, s12, s13
    buffer_load_dwordx4 v[32:35], v28, s[56:59], s12 offen sc1
    s_add_u32 s12, s12, 16384
    buffer_load_dwordx4 v[36:39], v28, s[56:59], s12 offen sc1
    s_add_u32 s12, s12, 16384
    buffer_load_dwordx4 v[40:43], v28, s[56:59], s12 offen sc1
    s_add_u32 s12, s12, 16384
    buffer_load_dwordx4 v[44:47], v28, s[56:59], s12 offen sc1
    s_add_u32 s12, s12, 16384
    buffer_load_dwordx4 v[48:51], v28, s[56:59], s12 offen sc1
    s_add_u32 s12, s12, 16384
    buffer_load_dwordx4 v[52:55], v28, s[56:59], s12 offen sc1
    s_add_u32 s12, s12, 16384
    buffer_load_dwordx4 v[56:59], v28, s[56:59], s12 offen sc1
    s_add_u32 s12, s12, 16384
    buffer_load_dwordx4 v[60:63], v28, s[56:59], s12 offen sc1
    s_add_u32 s12, s12, 16384
    s_waitcnt vmcnt(0)
    s_branch L_exit
L_B:
    buffer_load_dword v80, v99, s[56:59], s13 offen offset:0 sc1
    buffer_load_dword v81, v99, s[56:59], s13 offen offset:128 sc1
    buffer_load_dword v82, v99, s[56:59], s13 offen offset:256 sc1
    buffer_load_dword v83, v99, s[56:59], s13 offen offset:384 sc1
    v_lshlrev_b32 v12, 3, v4
    s_lshl_b32 s38, s4, 7
    s_add_u32 s38, s38, 8192
    buffer_load_dwordx2 v[14:15], v12, s[56:59], s38 offen sc1
    buffer_load_dword v32, v98, s[56:59], s12 offen offset:0 sc1
    buffer_load_dword v33, v98, s[56:59], s12 offen offset:1024 sc1
    buffer_load_dword v34, v98, s[56:59], s12 offen offset:2048 sc1
    buffer_load_dword v35, v98, s[56:59], s12 offen offset:3072 sc1
L_sb_9:
    ds_read_b32 v30, v1 offset:16
    s_waitcnt lgkmcnt(0)
    v_cmp_gt_u32 vcc, 4, v30
    s_nop 0
    s_cbranch_vccz L_sb_9d
    s_add_u32 s15, s15, 1
    s_cmp_gt_u32 s15, 100000
    s_cbranch_scc1 L_sb_9d
    s_branch L_sb_9
L_sb_9d:
    ds_read_b64_tr_b16 v[48:49], v10 offset:0
    ds_read_b64_tr_b16 v[50:51], v11 offset:0
    ds_read_b64_tr_b16 v[52:53], v10 offset:8192
    ds_read_b64_tr_b16 v[54:55], v11 offset:8192
    ds_read_b64_tr_b16 v[56:57], v10 offset:16384
    ds_read_b64_tr_b16 v[58:59], v11 offset:16384
    ds_read_b64_tr_b16 v[60:61], v10 offset:24576
    ds_read_b64_tr_b16 v[62:63], v11 offset:24576
    s_waitcnt vmcnt(4)
    s_branch L_bs_chk
L_bs_poll:
    buffer_load_dword v80, v99, s[56:59], s13 offen offset:0 sc1
    buffer_load_dword v81, v99, s[56:59], s13 offen offset:128 sc1
    buffer_load_dword v82, v99, s[56:59], s13 offen offset:256 sc1
    buffer_load_dword v83, v99, s[56:59], s13 offen offset:384 sc1
    s_waitcnt vmcnt(0)
L_bs_chk:
    v_max3_u32 v84, v80, v81, v82
    v_max_u32 v84, v84, v83
    v_cmp_eq_u32 vcc, -1, v84
    s_nop 0
    s_cbranch_vccz L_bs_got
    s_add_u32 s15, s15, 1
    s_cmp_gt_u32 s15, 100000
    s_cbranch_scc1 L_bs_got
    s_branch L_bs_poll
L_bs_got:
    v_max3_f32 v84, v80, v81, v82
    v_max_f32 v84, v84, v83
    v_sub_f32 v80, v80, v84
    v_sub_f32 v81, v81, v84
    v_sub_f32 v82, v82, v84
    v_sub_f32 v83, v83, v84
    v_exp_f32 v80, v80
    v_exp_f32 v81, v81
    v_exp_f32 v82, v82
    v_exp_f32 v83, v83
    s_nop 0
    v_add_f32 v84, v80, v81
    v_add_f32 v85, v82, v83
    v_add_f32 v84, v84, v85
    v_rcp_f32 v84, v84
    s_nop 0
    v_mul_f32 v124, v80, v84
    v_mul_f32 v126, v81, v84
    v_mul_f32 v128, v82, v84
    v_mul_f32 v130, v83, v84
    v_mov_b32 v125, v124
    v_mov_b32 v127, v126
    v_mov_b32 v129, v128
    v_mov_b32 v131, v130
    s_branch L_b_wait
L_b_poll:
    buffer_load_dword v32, v98, s[56:59], s12 offen offset:0 sc1
    buffer_load_dword v33, v98, s[56:59], s12 offen offset:1024 sc1
    buffer_load_dword v34, v98, s[56:59], s12 offen offset:2048 sc1
    buffer_load_dword v35, v98, s[56:59], s12 offen offset:3072 sc1
L_b_wait:
    s_waitcnt vmcnt(0)
    v_max3_u32 v36, v32, v33, v34
    v_max_u32 v36, v36, v35
    v_cmp_eq_u32 vcc, -1, v36
    s_nop 0
    s_cbranch_vccz L_b_got
    s_add_u32 s15, s15, 1
    s_cmp_gt_u32 s15, 100000
    s_cbranch_scc1 L_b_got
    s_branch L_b_poll
L_b_got:
    v_lshlrev_b32 v36, 16, v32
    v_and_b32 v37, 0xffff0000, v32
    v_lshlrev_b32 v38, 16, v33
    v_and_b32 v39, 0xffff0000, v33
    v_lshlrev_b32 v40, 16, v34
    v_and_b32 v41, 0xffff0000, v34
    v_lshlrev_b32 v42, 16, v35
    v_and_b32 v43, 0xffff0000, v35
    v_pk_mul_f32 v[44:45], v[36:37], v[124:125]
    v_pk_fma_f32 v[44:45], v[38:39], v[126:127], v[44:45]
    v_pk_fma_f32 v[44:45], v[40:41], v[128:129], v[44:45]
    v_pk_fma_f32 v[44:45], v[42:43], v[130:131], v[44:45]
    v_cvt_pk_bf16_f32 v44, v44, v45
    ds_write_b32 v22, v44
    s_waitcnt lgkmcnt(0)
    s_barrier
    ds_read_b128 v[32:35], v23 offset:0
    ds_read_b128 v[36:39], v23 offset:64
    ds_read_b128 v[40:43], v23 offset:128
    ds_read_b128 v[44:47], v23 offset:192
    s_waitcnt lgkmcnt(3)
    v_mfma_f32_16x16x32_bf16 v[64:67], v[48:51], v[32:35], 0
    s_waitcnt lgkmcnt(2)
    v_mfma_f32_16x16x32_bf16 v[64:67], v[52:55], v[36:39], v[64:67]
    s_waitcnt lgkmcnt(1)
    v_mfma_f32_16x16x32_bf16 v[64:67], v[56:59], v[40:43], v[64:67]
    s_waitcnt lgkmcnt(0)
    v_mfma_f32_16x16x32_bf16 v[64:67], v[60:63], v[44:47], v[64:67]
    s_mov_b32 exec_lo, 0xff00ff
    s_mov_b32 exec_hi, 0xff00ff
    s_cmp_eq_u32 s19, 8
    s_nop 4
    v_bfi_b32 v64, v13, v64, s21
    v_bfi_b32 v65, v13, v65, s21
    v_bfi_b32 v66, v13, v66, s21
    v_bfi_b32 v67, v13, v67, s21
    buffer_store_dwordx4 v[64:67], v25, s[56:59], s14 offen
    s_cbranch_scc1 L_hx_loc
    buffer_store_dwordx4 v[64:67], v25, s[56:59], s14 offen sc1
L_hx_loc:
    s_mov_b64 exec, -1
    s_cmp_lt_u32 s3, 4
    s_cbranch_scc0 L_exit
    buffer_load_dwordx4 v[32:35], v27, s[56:59], s22 offen sc1
    s_branch L_gv_10c
L_gv_10:
    buffer_load_dwordx2 v[14:15], v12, s[56:59], s38 offen sc1
    s_waitcnt vmcnt(0)
L_gv_10c:
    v_xor_b32 v14, s42, v14
    v_xor_b32 v15, s44, v15
    v_lshrrev_b32 v36, 1, v15
    v_or_b32 v14, v14, v36
    v_cmp_ne_u32 vcc, 0, v14
    s_nop 0
    s_cbranch_vccz L_gv_10d
    s_add_u32 s15, s15, 1
    s_cmp_gt_u32 s15, 100000
    s_cbranch_scc1 L_gv_10d
    s_sleep 4
    s_branch L_gv_10
L_gv_10d:
    v_cmp_eq_u32 vcc, 1, v15
    s_nop 1
    s_xor_b32 s39, vcc_lo, 0xf0f0
    s_and_b32 s39, s39, 0xffff
    s_bcnt1_i32_b32 s39, s39
    s_cmp_lt_u32 s39, 8
    s_movk_i32 s39, 0xf0
    s_cselect_b32 s39, s39, 15
    v_lshrrev_b32 v29, v3, s39
    v_lshrrev_b32 v17, 4, v29
    v_and_b32 v29, 1, v29
    v_and_b32 v17, 1, v17
    v_lshlrev_b32 v18, 18, v3
    v_lshl_add_u32 v18, v4, 4, v18
    v_lshl_add_u32 v29, v29, 13, v18
    v_lshl_add_u32 v17, v17, 13, v18
    s_add_u32 s24, s23, 1048576
    s_branch L_r1_wait
L_r1_poll:
    s_mov_b32 s13, s22
    buffer_load_dwordx4 v[32:35], v27, s[56:59], s13 offen sc1
L_r1_wait:
    s_waitcnt vmcnt(0)
    v_xor_b32 v32, s21, v32
    v_xor_b32 v33, s21, v33
    v_xor_b32 v34, s21, v34
    v_xor_b32 v35, s21, v35
    v_or3_b32 v62, v32, v33, v34
    v_or_b32 v62, v62, v35
    v_and_b32 v62, 0xfff, v62
    v_cmp_ne_u32 vcc, 0, v62
    s_nop 0
    s_cbranch_vccz L_r1_got
    s_add_u32 s15, s15, 1
    s_cmp_gt_u32 s15, 100000
    s_cbranch_scc1 L_r1_got
    s_branch L_r1_poll
L_r1_got:
    v_mov_b32 v36, v32
    v_mov_b32 v37, v33
    v_mov_b32 v38, v34
    v_mov_b32 v39, v35
    s_nop 0
    v_permlane16_swap_b32 v32, v36
    v_permlane16_swap_b32 v33, v37
    v_permlane16_swap_b32 v34, v38
    v_permlane16_swap_b32 v35, v39
    v_pk_add_f32 v[32:33], v[32:33], v[36:37]
    v_pk_add_f32 v[34:35], v[34:35], v[38:39]
    v_mov_b32 v36, v32
    v_mov_b32 v37, v33
    v_mov_b32 v38, v34
    v_mov_b32 v39, v35
    s_nop 0
    v_permlane32_swap_b32 v32, v36
    v_permlane32_swap_b32 v33, v37
    v_permlane32_swap_b32 v34, v38
    v_permlane32_swap_b32 v35, v39
    v_pk_add_f32 v[32:33], v[32:33], v[36:37]
    v_pk_add_f32 v[34:35], v[34:35], v[38:39]
    v_bfi_b32 v44, v13, v32, s20
    v_bfi_b32 v45, v13, v33, s20
    v_bfi_b32 v46, v13, v34, s20
    v_bfi_b32 v47, v13, v35, s20
    buffer_store_dwordx4 v[44:47], v29, s[56:59], s23 offen sc1
    buffer_store_dwordx4 v[44:47], v17, s[56:59], s24 offen sc1
    s_branch L_exit
L_R:
    s_lshl_b32 s20, s4, 17
    s_add_u32 s20, s20, 65536
    s_lshl_b32 s25, s3, 3
    s_add_u32 s25, s25, s9
    s_lshl_b32 s25, s25, 4
    s_lshl_b32 s22, s9, 3
    s_add_u32 s22, s22, s3
    s_lshl_b32 s22, s22, 10
    s_add_u32 s22, s22, s20
    s_add_u32 s25, s25, s20
    s_add_u32 s25, s25, 130048
    s_and_b32 s21, s42, 0xfff
    s_xor_b32 s21, s21, 0x80
    s_mov_b32 s18, s21
    v_and_b32 v19, 7, v4
    v_lshrrev_b32 v21, 3, v4
    s_lshl_b32 s14, s3, 4
    v_lshl_add_u32 v21, v21, 3, s14
    s_lshl_b32 s13, s9, 7
    v_lshl_add_u32 v23, v19, 10, v21
    v_add_u32 v23, s13, v23
    global_load_dwordx2 v[72:73], v23, s[16:17]
    v_lshlrev_b32 v22, 11, v3
    v_lshl_add_u32 v22, v4, 4, v22
    s_lshr_b32 s14, s39, s4
    s_and_b32 s14, s14, 1
    s_lshl_b32 s14, s14, 13
    s_lshl_b32 s12, s4, 18
    s_add_u32 s12, s12, s14
    s_lshl_b32 s13, s3, 15
    s_lshl_b32 s14, s9, 8
    s_add_u32 s13, s13, s14
    s_add_u32 s13, s13, 2097152
    s_add_u32 s12, s12, s13
    s_xor_b32 s13, s4, 4
    s_lshr_b32 s14, s39, s13
    s_and_b32 s14, s14, 1
    s_xor_b32 s14, s14, 1
    s_lshl_b32 s14, s14, 13
    s_lshl_b32 s26, s13, 18
    s_add_u32 s26, s26, s14
    s_add_u32 s26, s26, 2097152
    s_lshl_b32 s13, s3, 7
    s_add_u32 s26, s26, s13
    v_mov_b32 v13, 0xfffff000
    v_lshrrev_b32 v10, 1, v9
    s_lshl_b32 s14, s3, 1
    v_add_u32 v10, s14, v10
    v_lshlrev_b32 v11, 1, v8
    v_xor_b32 v10, v10, v11
    v_lshl_add_u32 v11, v3, 3, v8
    v_lshlrev_b32 v11, 9, v11
    v_and_b32 v12, 1, v9
    v_lshl_add_u32 v11, v12, 3, v11
    v_xor_b32 v12, 8, v10
    v_lshl_add_u32 v10, v10, 4, v11
    v_lshl_add_u32 v11, v12, 4, v11
    v_add_u32 v11, 2048, v11
    v_mul_u32_u24 v15, 144, v19
    v_add_u32 v15, 135168, v15
    v_add_u32 v14, v15, v21
    v_lshl_add_u32 v15, v3, 4, v15
    s_mul_i32 s14, s3, 144
    s_add_u32 s14, s14, 135168
    v_lshl_add_u32 v25, v4, 3, s14
    v_lshlrev_b32 v16, 7, v3
    v_lshl_add_u32 v16, v4, 4, v16
    v_lshlrev_b32 v24, 4, v3
    s_mul_i32 s13, s9, 896
    s_lshl_b32 s14, s3, 6
    s_add_u32 s13, s13, s14
    s_add_u32 s10, s13, s20
    s_add_u32 s10, s10, 122880
    s_lshl_b32 s27, s13, 3
    s_add_u32 s27, s27, s20
    s_add_u32 s27, s27, 65536
    s_add_u32 s11, s27, 4096
    v_mov_b32 v96, 0x3f803f80
    v_mov_b32 v97, 0x3f803f80
    v_mov_b32 v98, 0x3f803f80
    v_mov_b32 v99, 0x3f803f80
    s_waitcnt vmcnt(0)
L_sb_11:
    ds_read_b32 v30, v1 offset:16
    s_waitcnt lgkmcnt(0)
    v_cmp_gt_u32 vcc, 4, v30
    s_nop 0
    s_cbranch_vccz L_sb_11d
    s_add_u32 s15, s15, 1
    s_cmp_gt_u32 s15, 100000
    s_cbranch_scc1 L_sb_11d
    s_branch L_sb_11
L_sb_11d:
    ds_read_b64_tr_b16 v[100:101], v10 offset:0
    ds_read_b64_tr_b16 v[102:103], v11 offset:0
    ds_read_b64_tr_b16 v[104:105], v10 offset:16384
    ds_read_b64_tr_b16 v[106:107], v11 offset:16384
    ds_read_b64_tr_b16 v[108:109], v10 offset:256
    ds_read_b64_tr_b16 v[110:111], v11 offset:256
    ds_read_b64_tr_b16 v[112:113], v10 offset:16640
    ds_read_b64_tr_b16 v[114:115], v11 offset:16640
    s_waitcnt lgkmcnt(0)
    v_mfma_f32_16x16x32_bf16 v[116:119], v[100:103], v[96:99], 0
    v_mfma_f32_16x16x32_bf16 v[116:119], v[104:107], v[96:99], v[116:119]
    v_mfma_f32_16x16x32_bf16 v[120:123], v[108:111], v[96:99], 0
    v_mfma_f32_16x16x32_bf16 v[120:123], v[112:115], v[96:99], v[120:123]
    v_lshlrev_b32 v64, 16, v72
    v_and_b32 v65, 0xffff0000, v72
    v_lshlrev_b32 v66, 16, v73
    v_and_b32 v67, 0xffff0000, v73
    s_nop 3
    v_bfi_b32 v116, v13, v116, s18
    v_bfi_b32 v117, v13, v117, s18
    v_bfi_b32 v118, v13, v118, s18
    v_bfi_b32 v119, v13, v119, s18
    v_bfi_b32 v120, v13, v120, s18
    v_bfi_b32 v121, v13, v121, s18
    v_bfi_b32 v122, v13, v122, s18
    v_bfi_b32 v123, v13, v123, s18
L_pk_poll:
    s_mov_b32 s13, s22
    buffer_load_dwordx4 v[32:35], v27, s[56:59], s13 offen sc1
L_pk_wait:
    s_waitcnt vmcnt(0)
    v_xor_b32 v32, s21, v32
    v_xor_b32 v33, s21, v33
    v_xor_b32 v34, s21, v34
    v_xor_b32 v35, s21, v35
    v_or3_b32 v62, v32, v33, v34
    v_or_b32 v62, v62, v35
    v_and_b32 v62, 0xfff, v62
    v_cmp_ne_u32 vcc, 0, v62
    s_nop 0
    s_cbranch_vccz L_pk_got
    s_add_u32 s15, s15, 1
    s_cmp_gt_u32 s15, 100000
    s_cbranch_scc1 L_pk_got
    s_sleep 1
    s_branch L_pk_poll
L_pk_got:
    s_xor_b32 s21, s21, 0x80
    s_mov_b32 exec_lo, 0x10001
    s_mov_b32 exec_hi, 0x10001
    s_cmp_eq_u32 s19, 8
    buffer_store_dwordx4 v[116:119], v24, s[56:59], s10 offen
    s_cbranch_scc1 L_du_12
    buffer_store_dwordx4 v[116:119], v24, s[56:59], s10 offen sc1
L_du_12:
    s_cmp_lt_u32 s3, 6
    s_cbranch_scc0 L_sp_done
    s_cmp_eq_u32 s19, 8
    buffer_store_dwordx4 v[120:123], v24, s[56:59], s10 offen offset:512
    s_cbranch_scc1 L_du_13
    buffer_store_dwordx4 v[120:123], v24, s[56:59], s10 offen offset:512 sc1
L_du_13:
L_sp_done:
    s_mov_b64 exec, -1
    s_sleep 10
L_r_poll:
    s_mov_b32 s13, s12
    buffer_load_dwordx4 v[32:35], v22, s[56:59], s13 offen sc1
    s_add_u32 s13, s13, 16384
    buffer_load_dwordx4 v[36:39], v22, s[56:59], s13 offen sc1
L_r_wait:
    s_waitcnt vmcnt(0)
    v_xor_b32 v32, s21, v32
    v_xor_b32 v33, s21, v33
    v_xor_b32 v34, s21, v34
    v_xor_b32 v35, s21, v35
    v_xor_b32 v36, s21, v36
    v_xor_b32 v37, s21, v37
    v_xor_b32 v38, s21, v38
    v_xor_b32 v39, s21, v39
    v_or3_b32 v62, v32, v33, v34
    v_or3_b32 v62, v62, v35, v36
    v_or3_b32 v62, v62, v37, v38
    v_or_b32 v62, v62, v39
    v_and_b32 v62, 0xfff, v62
    v_cmp_ne_u32 vcc, 0, v62
    s_nop 0
    s_cbranch_vccz L_r_got
    s_add_u32 s15, s15, 1
    s_cmp_gt_u32 s15, 100000
    s_cbranch_scc1 L_r_got
    s_branch L_r_poll
L_r_got:
    v_pk_add_f32 v[32:33], v[32:33], v[36:37]
    v_pk_add_f32 v[34:35], v[34:35], v[38:39]
    v_mov_b32 v36, v32
    v_mov_b32 v37, v33
    v_mov_b32 v38, v34
    v_mov_b32 v39, v35
    s_nop 0
    v_permlane16_swap_b32 v32, v36
    v_permlane16_swap_b32 v33, v37
    v_permlane16_swap_b32 v34, v38
    v_permlane16_swap_b32 v35, v39
    v_pk_add_f32 v[32:33], v[32:33], v[36:37]
    v_pk_add_f32 v[34:35], v[34:35], v[38:39]
    v_mov_b32 v36, v32
    v_mov_b32 v37, v33
    v_mov_b32 v38, v34
    v_mov_b32 v39, v35
    s_nop 0
    v_permlane32_swap_b32 v32, v36
    v_permlane32_swap_b32 v33, v37
    v_permlane32_swap_b32 v34, v38
    v_permlane32_swap_b32 v35, v39
    v_pk_add_f32 v[32:33], v[32:33], v[36:37]
    v_pk_add_f32 v[34:35], v[34:35], v[38:39]
    v_cvt_pk_bf16_f32 v40, v32, v33
    v_lshlrev_b32 v32, 16, v40
    v_and_b32 v33, 0xffff0000, v40
    v_cvt_pk_bf16_f32 v41, v34, v35
    v_lshlrev_b32 v34, 16, v41
    v_and_b32 v35, 0xffff0000, v41
    v_pk_add_f32 v[32:33], v[32:33], v[64:65]
    v_pk_add_f32 v[34:35], v[34:35], v[66:67]
    v_cvt_pk_bf16_f32 v76, v32, v33
    v_cvt_pk_bf16_f32 v77, v34, v35
    ds_write_b64 v14, v[76:77]
    s_xor_b32 s21, s21, 0x80
    s_waitcnt lgkmcnt(0)
    s_barrier
    ds_read_b64 v[76:77], v25
    ds_read_b128 v[96:99], v15
    ds_read_b128 v[92:95], v15 offset:64
    s_waitcnt lgkmcnt(0)
    v_mfma_f32_16x16x32_bf16 v[116:119], v[100:103], v[96:99], 0
    v_mfma_f32_16x16x32_bf16 v[116:119], v[104:107], v[92:95], v[116:119]
    v_mfma_f32_16x16x32_bf16 v[120:123], v[108:111], v[96:99], 0
    v_mfma_f32_16x16x32_bf16 v[120:123], v[112:115], v[92:95], v[120:123]
    v_lshlrev_b32 v64, 16, v76
    v_and_b32 v65, 0xffff0000, v76
    v_readfirstlane_b32 s13, v64
    v_lshlrev_b32 v66, 16, v77
    v_and_b32 v67, 0xffff0000, v77
    s_mov_b32 exec_lo, 0x00ff00ff
    s_mov_b32 exec_hi, 0x00ff00ff
    s_cmp_eq_u32 s19, 8
    v_bfi_b32 v116, v13, v116, s21
    v_bfi_b32 v117, v13, v117, s21
    v_bfi_b32 v118, v13, v118, s21
    v_bfi_b32 v119, v13, v119, s21
    buffer_store_dwordx4 v[116:119], v16, s[56:59], s27 offen
    s_cbranch_scc1 L_du_14
    buffer_store_dwordx4 v[116:119], v16, s[56:59], s27 offen sc1
L_du_14:
    s_cmp_lt_u32 s3, 6
    s_cbranch_scc0 L_z_done
    s_cmp_eq_u32 s19, 8
    v_bfi_b32 v120, v13, v120, s21
    v_bfi_b32 v121, v13, v121, s21
    v_bfi_b32 v122, v13, v122, s21
    v_bfi_b32 v123, v13, v123, s21
    buffer_store_dwordx4 v[120:123], v16, s[56:59], s11 offen
    s_cbranch_scc1 L_du_15
    buffer_store_dwordx4 v[120:123], v16, s[56:59], s11 offen sc1
L_du_15:
L_z_done:
    s_mov_b64 exec, -1
    v_subrev_f32 v32, s13, v64
    v_subrev_f32 v33, s13, v65
    v_subrev_f32 v34, s13, v66
    v_subrev_f32 v35, s13, v67
    v_mul_f32 v40, v32, v32
    v_add_f32 v41, v32, v33
    v_fmac_f32 v40, v33, v33
    v_add_f32 v42, v34, v35
    v_fmac_f32 v40, v34, v34
    v_add_f32 v41, v41, v42
    v_fmac_f32 v40, v35, v35
    s_nop 0
    v_add_f32_dpp v41, v41, v41 quad_perm:[1,0,3,2] row_mask:0xf bank_mask:0xf
    v_add_f32_dpp v40, v40, v40 quad_perm:[1,0,3,2] row_mask:0xf bank_mask:0xf
    s_nop 0
    v_add_f32_dpp v41, v41, v41 quad_perm:[2,3,0,1] row_mask:0xf bank_mask:0xf
    v_add_f32_dpp v40, v40, v40 quad_perm:[2,3,0,1] row_mask:0xf bank_mask:0xf
    s_nop 0
    v_add_f32_dpp v41, v41, v41 row_half_mirror row_mask:0xf bank_mask:0xf
    v_add_f32_dpp v40, v40, v40 row_half_mirror row_mask:0xf bank_mask:0xf
    s_nop 0
    v_add_f32_dpp v41, v41, v41 row_mirror row_mask:0xf bank_mask:0xf
    v_add_f32_dpp v40, v40, v40 row_mirror row_mask:0xf bank_mask:0xf
    v_mov_b32 v80, s42
    v_mul_f32 v42, 0x3c800000, v41
    v_mov_b32 v81, s43
    v_fma_f32 v79, -v42, v41, v40
    v_add_f32 v78, s13, v42
    v_max_f32 v79, 0, v79
    s_mov_b64 exec, 1
    s_cmp_eq_u32 s19, 8
    buffer_store_dwordx4 v[78:81], v27, s[56:59], s25 offen
    s_cbranch_scc1 L_du_16
    buffer_store_dwordx4 v[78:81], v27, s[56:59], s25 offen sc1
L_du_16:
    s_mov_b64 exec, -1
    s_xor_b32 s21, s21, 0x80
    s_xor_b32 s13, s9, s4
    s_cmp_lt_u32 s13, 2
    s_cbranch_scc0 L_exit
    s_lshl_b32 s14, s13, 16
    s_add_u32 s26, s26, s14
    v_lshl_add_u32 v28, v5, 10, v6
    s_lshl_b32 s14, s13, 6
    s_and_b32 s13, s3, 1
    s_lshl_b32 s13, s13, 5
    s_add_u32 s14, s14, s13
    s_lshr_b32 s13, s3, 1
    s_lshl_b32 s13, s13, 3
    s_add_u32 s14, s14, s13
    v_and_b32 v29, 7, v2
    v_mul_u32_u24 v30, 144, v29
    s_add_u32 s13, s14, 135168
    v_add_u32 v30, s13, v30
    ds_read_b64 v[86:87], v30
    s_lshl_b32 s13, s9, 7
    s_add_u32 s14, s14, s13
    v_mov_b32 v30, s14
    global_load_dwordx2 v[88:89], v30, s[34:35]
    v_lshl_add_u32 v23, v29, 10, s14
    s_waitcnt vmcnt(0) lgkmcnt(0)
    v_lshlrev_b32 v64, 16, v86
    v_and_b32 v65, 0xffff0000, v86
    v_lshlrev_b32 v66, 16, v87
    v_and_b32 v67, 0xffff0000, v87
    v_lshlrev_b32 v68, 16, v88
    v_and_b32 v69, 0xffff0000, v88
    v_lshlrev_b32 v70, 16, v89
    v_and_b32 v71, 0xffff0000, v89
    s_sleep 20
L_d_poll:
    s_mov_b32 s13, s26
    buffer_load_dwordx4 v[32:35], v28, s[56:59], s13 offen sc1
    s_add_u32 s13, s13, 16384
    buffer_load_dwordx4 v[36:39], v28, s[56:59], s13 offen sc1
    s_add_u32 s13, s13, 16384
    buffer_load_dwordx4 v[40:43], v28, s[56:59], s13 offen sc1
    s_add_u32 s13, s13, 16384
    buffer_load_dwordx4 v[44:47], v28, s[56:59], s13 offen sc1
L_d_wait:
    s_waitcnt vmcnt(0)
    v_xor_b32 v32, s21, v32
    v_xor_b32 v33, s21, v33
    v_xor_b32 v34, s21, v34
    v_xor_b32 v35, s21, v35
    v_xor_b32 v36, s21, v36
    v_xor_b32 v37, s21, v37
    v_xor_b32 v38, s21, v38
    v_xor_b32 v39, s21, v39
    v_xor_b32 v40, s21, v40
    v_xor_b32 v41, s21, v41
    v_xor_b32 v42, s21, v42
    v_xor_b32 v43, s21, v43
    v_xor_b32 v44, s21, v44
    v_xor_b32 v45, s21, v45
    v_xor_b32 v46, s21, v46
    v_xor_b32 v47, s21, v47
    v_or3_b32 v62, v32, v33, v34
    v_or3_b32 v62, v62, v35, v36
    v_or3_b32 v62, v62, v37, v38
    v_or3_b32 v62, v62, v39, v40
    v_or3_b32 v62, v62, v41, v42
    v_or3_b32 v62, v62, v43, v44
    v_or3_b32 v62, v62, v45, v46
    v_or_b32 v62, v62, v47
    v_and_b32 v62, 0xfff, v62
    v_cmp_ne_u32 vcc, 0, v62
    s_nop 0
    s_cbranch_vccz L_d_got
    s_add_u32 s15, s15, 1
    s_cmp_gt_u32 s15, 100000
    s_cbranch_scc1 L_d_got
    s_branch L_d_poll
L_d_got:
    v_pk_add_f32 v[32:33], v[32:33], v[40:41]
    v_pk_add_f32 v[34:35], v[34:35], v[42:43]
    v_pk_add_f32 v[36:37], v[36:37], v[44:45]
    v_pk_add_f32 v[38:39], v[38:39], v[46:47]
    v_pk_add_f32 v[32:33], v[32:33], v[36:37]
    v_pk_add_f32 v[34:35], v[34:35], v[38:39]
    s_nop 1
    v_add_f32_dpp v32, v32, v32 row_ror:8 row_mask:0xf bank_mask:0xf
    v_add_f32_dpp v33, v33, v33 row_ror:8 row_mask:0xf bank_mask:0xf
    v_add_f32_dpp v34, v34, v34 row_ror:8 row_mask:0xf bank_mask:0xf
    v_add_f32_dpp v35, v35, v35 row_ror:8 row_mask:0xf bank_mask:0xf
    v_mov_b32 v36, v32
    v_mov_b32 v37, v33
    v_mov_b32 v38, v34
    v_mov_b32 v39, v35
    s_nop 0
    v_permlane16_swap_b32 v32, v36
    v_permlane16_swap_b32 v33, v37
    v_permlane16_swap_b32 v34, v38
    v_permlane16_swap_b32 v35, v39
    v_pk_add_f32 v[32:33], v[32:33], v[36:37]
    v_pk_add_f32 v[34:35], v[34:35], v[38:39]
    v_mov_b32 v36, v32
    v_mov_b32 v37, v33
    v_mov_b32 v38, v34
    v_mov_b32 v39, v35
    s_nop 0
    v_permlane32_swap_b32 v32, v36
    v_permlane32_swap_b32 v33, v37
    v_permlane32_swap_b32 v34, v38
    v_permlane32_swap_b32 v35, v39
    v_pk_add_f32 v[32:33], v[32:33], v[36:37]
    v_pk_add_f32 v[34:35], v[34:35], v[38:39]
    v_cvt_pk_bf16_f32 v40, v32, v33
    v_lshlrev_b32 v32, 16, v40
    v_and_b32 v33, 0xffff0000, v40
    v_cvt_pk_bf16_f32 v41, v34, v35
    v_lshlrev_b32 v34, 16, v41
    v_and_b32 v35, 0xffff0000, v41
    v_pk_add_f32 v[32:33], v[32:33], v[68:69]
    v_pk_add_f32 v[34:35], v[34:35], v[70:71]
    v_cvt_pk_bf16_f32 v40, v32, v33
    v_lshlrev_b32 v32, 16, v40
    v_and_b32 v33, 0xffff0000, v40
    v_cvt_pk_bf16_f32 v41, v34, v35
    v_lshlrev_b32 v34, 16, v41
    v_and_b32 v35, 0xffff0000, v41
    v_pk_add_f32 v[32:33], v[32:33], v[64:65]
    v_pk_add_f32 v[34:35], v[34:35], v[66:67]
    v_cvt_pk_bf16_f32 v36, v32, v33
    v_cvt_pk_bf16_f32 v37, v34, v35
    s_mov_b64 exec, 0xff
    global_store_dwordx2 v23, v[36:37], s[36:37]
    s_or_b32 s13, s9, s3
    s_or_b32 s13, s13, s4
    s_cmp_eq_u32 s13, 0
    s_cbranch_scc0 L_d_noep
    v_mov_b32 v34, s42
    v_mov_b32 v35, s43
    s_mov_b64 exec, 1
    global_store_dwordx2 v27, v[34:35], s[40:41] offset:0
L_d_noep:
    s_mov_b64 exec, -1
    s_branch L_exit
L_C:
    s_lshl_b32 s22, s4, 2
    s_add_u32 s22, s22, s9
    s_lshl_b32 s20, s4, 17
    s_add_u32 s20, s20, 65536
    v_lshrrev_b32 v22, 5, v2
    v_lshl_add_u32 v22, v22, 2, v9
    s_lshl_b32 s13, s3, 3
    v_add_u32 v22, s13, v22
    v_bfe_u32 v23, v2, 2, 3
    v_mul_u32_u24 v14, 144, v23
    v_lshl_add_u32 v14, v22, 1, v14
    v_add_u32 v14, 131072, v14
    v_min_u32 v22, 55, v22
    s_mul_i32 s13, s22, 112
    v_lshl_add_u32 v28, v22, 1, s13
    global_load_ushort v120, v28, s[30:31]
    s_lshl_b32 s10, s3, 13
    v_add_u32 v18, s10, v20
    v_and_b32 v15, 7, v4
    v_lshlrev_b32 v16, 7, v15
    v_lshl_add_u32 v16, v3, 4, v16
    v_mul_u32_u24 v15, 144, v15
    v_lshl_add_u32 v15, v3, 4, v15
    v_add_u32 v15, 131072, v15
    s_xor_b32 s13, s3, 4
    s_lshr_b32 s14, s39, s13
    s_and_b32 s14, s14, 1
    s_xor_b32 s14, s14, 1
    s_lshl_b32 s14, s14, 13
    s_lshl_b32 s26, s13, 18
    s_add_u32 s26, s26, s14
    s_add_u32 s26, s26, 2097152
    s_xor_b32 s11, s3, 1
    s_xor_b32 s13, s11, 4
    s_lshr_b32 s14, s39, s13
    s_and_b32 s14, s14, 1
    s_xor_b32 s14, s14, 1
    s_lshl_b32 s14, s14, 13
    s_lshl_b32 s61, s13, 18
    s_add_u32 s61, s61, s14
    s_add_u32 s61, s61, 2097152
    s_lshr_b32 s13, s22, 3
    s_lshl_b32 s13, s13, 14
    s_and_b32 s14, s22, 7
    s_lshl_b32 s14, s14, 10
    s_add_u32 s13, s13, s14
    s_add_u32 s26, s26, s13
    s_add_u32 s61, s61, s13
    s_add_u32 s61, s61, 65536
    s_and_b32 s21, s42, 0xfff
    s_xor_b32 s25, s21, 0x80
    v_mov_b32 v123, 0xfffff000
    v_lshlrev_b32 v11, 2, v22
    v_lshlrev_b32 v10, 2, v2
    s_mul_i32 s13, s9, 224
    s_add_u32 s24, s13, s20
    s_add_u32 s24, s24, 122880
    s_add_u32 s18, s24, 3584
    s_lshl_b32 s12, s13, 3
    s_lshl_b32 s13, s3, 8
    s_add_u32 s12, s12, s13
    s_add_u32 s12, s12, s20
    s_add_u32 s12, s12, 65536
    s_add_u32 s27, s20, 130048
    v_lshlrev_b32 v12, 7, v23
    v_lshl_add_u32 v12, v9, 4, v12
    v_cmp_lt_u32 s[48:49], 7, v4
    v_lshrrev_b32 v17, 3, v4
    v_lshl_add_u32 v17, v17, 6, v16
L_sb_17:
    ds_read_b32 v30, v1 offset:16
    s_waitcnt lgkmcnt(0)
    v_cmp_gt_u32 vcc, 4, v30
    s_nop 0
    s_cbranch_vccz L_sb_17d
    s_add_u32 s15, s15, 1
    s_cmp_gt_u32 s15, 100000
    s_cbranch_scc1 L_sb_17d
    s_branch L_sb_17
L_sb_17d:
    ds_read_b64_tr_b16 v[48:49], v18 offset:0
    ds_read_b64_tr_b16 v[50:51], v18 offset:512
    ds_read_b64_tr_b16 v[52:53], v18 offset:4096
    ds_read_b64_tr_b16 v[54:55], v18 offset:4608
    ds_read_b64_tr_b16 v[56:57], v18 offset:32
    ds_read_b64_tr_b16 v[58:59], v18 offset:544
    ds_read_b64_tr_b16 v[60:61], v18 offset:4128
    ds_read_b64_tr_b16 v[62:63], v18 offset:4640
    ds_read_b64_tr_b16 v[64:65], v18 offset:64
    ds_read_b64_tr_b16 v[66:67], v18 offset:576
    ds_read_b64_tr_b16 v[68:69], v18 offset:4160
    ds_read_b64_tr_b16 v[70:71], v18 offset:4672
    s_waitcnt lgkmcnt(4)
    ds_read_b64_tr_b16 v[72:73], v18 offset:96
    ds_read_b64_tr_b16 v[74:75], v18 offset:608
    ds_read_b64_tr_b16 v[76:77], v18 offset:4192
    ds_read_b64_tr_b16 v[78:79], v18 offset:4704
    s_cmp_eq_u32 s3, 7
    s_cbranch_scc0 L_c_work
    v_mov_b32 v96, 0
    ds_write_b16 v14, v96
    s_branch L_c_skip
L_c_work:
L_s_poll:
    buffer_load_dword v96, v11, s[56:59], s24 offen offset:0 sc1
    buffer_load_dword v97, v11, s[56:59], s24 offen offset:896 sc1
    buffer_load_dword v98, v11, s[56:59], s24 offen offset:1792 sc1
    buffer_load_dword v99, v11, s[56:59], s24 offen offset:2688 sc1
    buffer_load_dword v100, v11, s[56:59], s18 offen offset:0 sc1
    buffer_load_dword v101, v11, s[56:59], s18 offen offset:896 sc1
    buffer_load_dword v102, v11, s[56:59], s18 offen offset:1792 sc1
    buffer_load_dword v103, v11, s[56:59], s18 offen offset:2688 sc1
    s_waitcnt vmcnt(0)
    v_xor_b32 v96, s25, v96
    v_xor_b32 v97, s25, v97
    v_xor_b32 v98, s25, v98
    v_xor_b32 v99, s25, v99
    v_xor_b32 v100, s25, v100
    v_xor_b32 v101, s25, v101
    v_xor_b32 v102, s25, v102
    v_xor_b32 v103, s25, v103
    v_or3_b32 v108, v96, v97, v98
    v_or3_b32 v109, v99, v100, v101
    v_or3_b32 v108, v108, v102, v103
    v_or_b32 v108, v108, v109
    v_and_b32 v108, 0xfff, v108
    v_cmp_ne_u32 vcc, 0, v108
    s_nop 0
    s_cbranch_vccz L_s_got
    s_add_u32 s15, s15, 1
    s_cmp_gt_u32 s15, 100000
    s_cbranch_scc1 L_s_got
    s_sleep 4
    s_branch L_s_poll
L_s_got:
    v_pk_add_f32 v[96:97], v[96:97], v[98:99]
    v_pk_add_f32 v[100:101], v[100:101], v[102:103]
    v_pk_add_f32 v[96:97], v[96:97], v[100:101]
    v_add_f32 v96, v96, v97
    v_mov_b32 v121, v96
    v_lshlrev_b32 v120, 16, v120
L_c_poll:
    s_mov_b32 s13, s12
    buffer_load_dword v96, v10, s[56:59], s13 offen sc1
    s_add_u32 s13, s13, 7168
    buffer_load_dword v97, v10, s[56:59], s13 offen sc1
    s_add_u32 s13, s13, 7168
    buffer_load_dword v98, v10, s[56:59], s13 offen sc1
    s_add_u32 s13, s13, 7168
    buffer_load_dword v99, v10, s[56:59], s13 offen sc1
    s_add_u32 s13, s13, 7168
    buffer_load_dword v100, v10, s[56:59], s13 offen sc1
    s_add_u32 s13, s13, 7168
    buffer_load_dword v101, v10, s[56:59], s13 offen sc1
    s_add_u32 s13, s13, 7168
    buffer_load_dword v102, v10, s[56:59], s13 offen sc1
    s_add_u32 s13, s13, 7168
    buffer_load_dword v103, v10, s[56:59], s13 offen sc1
    buffer_load_dwordx4 v[104:107], v12, s[56:59], s27 offen sc1
    buffer_load_dwordx4 v[112:115], v12, s[56:59], s27 offen offset:64 sc1
    s_waitcnt vmcnt(0)
    v_xor_b32 v106, s42, v106
    v_xor_b32 v107, s43, v107
    v_xor_b32 v114, s42, v114
    v_xor_b32 v115, s43, v115
    v_pk_add_f32 v[28:29], v[104:105], v[112:113]
    v_or3_b32 v106, v106, v107, v114
    v_xor_b32 v96, s25, v96
    v_xor_b32 v97, s25, v97
    v_xor_b32 v98, s25, v98
    v_xor_b32 v99, s25, v99
    v_xor_b32 v100, s25, v100
    v_xor_b32 v101, s25, v101
    v_xor_b32 v102, s25, v102
    v_xor_b32 v103, s25, v103
    v_or3_b32 v108, v96, v97, v98
    v_or3_b32 v109, v99, v100, v101
    v_or3_b32 v108, v108, v102, v103
    v_or_b32 v108, v108, v109
    v_and_b32 v108, 0xfff, v108
    v_or3_b32 v108, v108, v106, v115
    v_cmp_ne_u32 vcc, 0, v108
    v_add_f32_dpp v28, v28, v28 quad_perm:[1,0,3,2] row_mask:0xf bank_mask:0xf
    v_add_f32_dpp v29, v29, v29 quad_perm:[1,0,3,2] row_mask:0xf bank_mask:0xf
    s_cbranch_vccz L_c_got
    s_add_u32 s15, s15, 1
    s_cmp_gt_u32 s15, 100000
    s_cbranch_scc1 L_c_got
    s_branch L_c_poll
L_c_got:
    v_pk_add_f32 v[96:97], v[96:97], v[98:99]
    v_add_f32_dpp v28, v28, v28 quad_perm:[2,3,0,1] row_mask:0xf bank_mask:0xf
    v_add_f32_dpp v29, v29, v29 quad_perm:[2,3,0,1] row_mask:0xf bank_mask:0xf
    v_pk_add_f32 v[100:101], v[100:101], v[102:103]
    v_mul_f32 v28, 0x3e000000, v28
    v_sub_f32 v30, v104, v28
    v_sub_f32 v31, v112, v28
    v_mul_f32 v30, v30, v30
    v_fmac_f32 v30, v31, v31
    v_pk_add_f32 v[96:97], v[96:97], v[100:101]
    v_add_f32 v96, v96, v97
    v_add_f32_dpp v30, v30, v30 quad_perm:[1,0,3,2] row_mask:0xf bank_mask:0xf
    s_nop 1
    v_add_f32_dpp v30, v30, v30 quad_perm:[2,3,0,1] row_mask:0xf bank_mask:0xf
    v_fmac_f32 v29, 0x42800000, v30
    v_mul_f32 v29, 0x3b000000, v29
    v_cvt_pk_bf16_f32 v30, v28, v29
    v_and_b32 v31, 0xffff0000, v30
    v_add_f32 v31, 0x3727c5ac, v31
    v_lshlrev_b32 v30, 16, v30
    v_cvt_pk_bf16_f32 v31, v31, v31
    v_and_b32 v31, 0xffff0000, v31
    v_sqrt_f32 v31, v31
    v_sub_f32 v28, v28, v30
    v_cvt_pk_bf16_f32 v31, v31, v31
    v_and_b32 v31, 0xffff0000, v31
    v_rcp_f32 v31, v31
    s_nop 0
    v_mul_f32 v28, v28, v31
    v_mul_f32 v29, v29, v31
    v_mul_f32 v29, v29, v31
    v_cvt_pk_bf16_f32 v28, v28, v29
    v_and_b32 v29, 0xffff0000, v28
    v_add_f32 v29, 0x3727c5ac, v29
    v_lshlrev_b32 v28, 16, v28
    v_cvt_pk_bf16_f32 v29, v29, v29
    v_and_b32 v29, 0xffff0000, v29
    v_sqrt_f32 v29, v29
    v_fmac_f32 v28, v30, v31
    v_cvt_pk_bf16_f32 v29, v29, v29
    v_and_b32 v29, 0xffff0000, v29
    v_rcp_f32 v29, v29
    v_mul_f32 v96, v96, v31
    v_fma_f32 v96, -v28, v121, v96
    v_mul_f32 v96, v96, v29
    v_cvt_pk_bf16_f32 v96, v96, v96
    v_and_b32 v96, 0xffff0000, v96
    v_add_f32 v96, v96, v120
    v_cvt_pk_bf16_f32 v96, v96, v96
    v_and_b32 v96, 0xffff0000, v96
    v_mul_f32 v97, v96, v96
    v_mov_b32 v98, 0xc0135761
    v_fmac_f32 v98, 0xbdd2d3e8, v97
    v_mul_f32 v97, v98, v96
    v_exp_f32 v97, v97
    s_nop 0
    v_add_f32 v97, 1.0, v97
    v_rcp_f32 v97, v97
    s_nop 0
    v_mul_f32 v96, v96, v97
    v_cvt_pk_bf16_f32 v96, v96, v96
    ds_write_b16 v14, v96
L_c_skip:
    s_waitcnt lgkmcnt(0)
    s_barrier
    ds_read_b128 v[96:99], v15
    ds_read_b128 v[100:103], v15 offset:64
    s_waitcnt lgkmcnt(0)
    v_mfma_f32_16x16x32_bf16 v[124:127], v[48:51], v[96:99], 0
    v_mfma_f32_16x16x32_bf16 v[124:127], v[52:55], v[100:103], v[124:127]
    v_mfma_f32_16x16x32_bf16 v[128:131], v[56:59], v[96:99], 0
    v_mfma_f32_16x16x32_bf16 v[128:131], v[60:63], v[100:103], v[128:131]
    v_mfma_f32_16x16x32_bf16 v[132:135], v[64:67], v[96:99], 0
    v_mfma_f32_16x16x32_bf16 v[132:135], v[68:71], v[100:103], v[132:135]
    v_mfma_f32_16x16x32_bf16 v[136:139], v[72:75], v[96:99], 0
    v_mfma_f32_16x16x32_bf16 v[136:139], v[76:79], v[100:103], v[136:139]
    s_nop 3
    v_cndmask_b32 v124, v124, v128, s[48:49]
    v_cndmask_b32 v125, v125, v129, s[48:49]
    v_cndmask_b32 v126, v126, v130, s[48:49]
    v_cndmask_b32 v127, v127, v131, s[48:49]
    v_bfi_b32 v124, v123, v124, s21
    v_bfi_b32 v125, v123, v125, s21
    v_bfi_b32 v126, v123, v126, s21
    v_bfi_b32 v127, v123, v127, s21
    buffer_store_dwordx4 v[124:127], v27, s[56:59], s26 offen sc1
    v_cndmask_b32 v132, v132, v136, s[48:49]
    v_cndmask_b32 v133, v133, v137, s[48:49]
    v_cndmask_b32 v134, v134, v138, s[48:49]
    v_cndmask_b32 v135, v135, v139, s[48:49]
    v_bfi_b32 v132, v123, v132, s21
    v_bfi_b32 v133, v123, v133, s21
    v_bfi_b32 v134, v123, v134, s21
    v_bfi_b32 v135, v123, v135, s21
    buffer_store_dwordx4 v[132:135], v27, s[56:59], s61 offen sc1
L_exit:
L_end:
    s_endpgm
L_loader:
    s_sub_u32 s3, s3, 8
    v_xor_b32 v28, v4, v3
    v_lshlrev_b32 v21, 8, v3
    v_xor_b32 v23, 0, v28
    v_lshl_add_u32 v10, v23, 4, v21
    v_xor_b32 v23, 4, v28
    v_lshl_add_u32 v11, v23, 4, v21
    v_xor_b32 v23, 8, v28
    v_lshl_add_u32 v12, v23, 4, v21
    v_xor_b32 v23, 12, v28
    v_lshl_add_u32 v13, v23, 4, v21
    s_mul_i32 s10, s3, 16384
    s_lshl_b32 s11, s6, 3
    s_add_u32 s11, s11, s4
    s_lshl_b32 s11, s11, 20
    s_add_u32 s11, s11, 786432
    s_lshl_b32 s12, s7, 16
    s_add_u32 s11, s11, s12
    s_add_u32 s11, s11, s10
    v_lshlrev_b32 v23, 1, v3
    v_xor_b32 v23, v23, v4
    v_lshl_add_u32 v14, v23, 4, v21
    v_xor_b32 v23, 8, v23
    v_lshl_add_u32 v15, v23, 4, v21
    v_mov_b32 v31, 1
    v_lshrrev_b32 v26, 2, v2
    v_lshlrev_b32 v26, 10, v26
    v_and_b32 v23, 3, v2
    v_lshl_add_u32 v26, v23, 4, v26
    s_waitcnt lgkmcnt(0)
    s_mov_b32 s44, s18
    s_mov_b32 s45, s19
    s_mov_b32 s46, 0x4000000
    s_mov_b32 s47, 0x20000
    s_mov_b32 s48, s20
    s_mov_b32 s49, s21
    s_mov_b32 s50, 0x4000000
    s_mov_b32 s51, 0x20000
    s_add_u32 s20, s4, s5
    s_lshl_b32 s20, s20, 12
    s_barrier
    s_sleep 4
    s_add_u32 s21, s20, 0
    s_and_b32 s21, s21, 0x3000
    s_add_u32 s13, s10, s21
    s_add_u32 s13, s13, 0
    s_mov_b32 m0, s13
    s_add_u32 s12, s11, s21
    buffer_load_dwordx4 v10, s[44:47], s12 offen offset:0 nt lds
    buffer_load_dwordx4 v11, s[44:47], s12 offen offset:1024 nt lds
    buffer_load_dwordx4 v12, s[44:47], s12 offen offset:2048 nt lds
    buffer_load_dwordx4 v13, s[44:47], s12 offen offset:3072 nt lds
    s_waitcnt vmcnt(3)
    s_add_u32 s21, s20, 4096
    s_and_b32 s21, s21, 0x3000
    s_add_u32 s13, s10, s21
    s_add_u32 s13, s13, 0
    s_mov_b32 m0, s13
    s_add_u32 s12, s11, s21
    buffer_load_dwordx4 v10, s[44:47], s12 offen offset:0 nt lds
    s_waitcnt vmcnt(3)
    buffer_load_dwordx4 v11, s[44:47], s12 offen offset:1024 nt lds
    s_waitcnt vmcnt(3)
    buffer_load_dwordx4 v12, s[44:47], s12 offen offset:2048 nt lds
    s_waitcnt vmcnt(3)
    buffer_load_dwordx4 v13, s[44:47], s12 offen offset:3072 nt lds
    s_waitcnt vmcnt(3)
    s_add_u32 s21, s20, 8192
    s_and_b32 s21, s21, 0x3000
    s_add_u32 s13, s10, s21
    s_add_u32 s13, s13, 0
    s_mov_b32 m0, s13
    s_add_u32 s12, s11, s21
    buffer_load_dwordx4 v10, s[44:47], s12 offen offset:0 nt lds
    s_waitcnt vmcnt(3)
    buffer_load_dwordx4 v11, s[44:47], s12 offen offset:1024 nt lds
    s_waitcnt vmcnt(3)
    buffer_load_dwordx4 v12, s[44:47], s12 offen offset:2048 nt lds
    s_waitcnt vmcnt(3)
    buffer_load_dwordx4 v13, s[44:47], s12 offen offset:3072 nt lds
    s_waitcnt vmcnt(3)
    s_add_u32 s21, s20, 12288
    s_and_b32 s21, s21, 0x3000
    s_add_u32 s13, s10, s21
    s_add_u32 s13, s13, 0
    s_mov_b32 m0, s13
    s_add_u32 s12, s11, s21
    buffer_load_dwordx4 v10, s[44:47], s12 offen offset:0 nt lds
    s_waitcnt vmcnt(3)
    buffer_load_dwordx4 v11, s[44:47], s12 offen offset:1024 nt lds
    s_waitcnt vmcnt(3)
    buffer_load_dwordx4 v12, s[44:47], s12 offen offset:2048 nt lds
    s_waitcnt vmcnt(3)
    buffer_load_dwordx4 v13, s[44:47], s12 offen offset:3072 nt lds
    s_waitcnt vmcnt(3)
    s_add_u32 s21, s20, 0
    s_and_b32 s21, s21, 0x3000
    s_add_u32 s13, s10, s21
    s_add_u32 s13, s13, 65536
    s_mov_b32 m0, s13
    s_add_u32 s12, s11, s21
    buffer_load_dwordx4 v14, s[48:51], s12 offen offset:0 nt lds
    s_waitcnt vmcnt(3)
    buffer_load_dwordx4 v15, s[48:51], s12 offen offset:1024 nt lds
    s_waitcnt vmcnt(3)
    buffer_load_dwordx4 v14, s[48:51], s12 offen offset:2048 nt lds
    s_waitcnt vmcnt(3)
    s_mov_b64 exec, 1
    ds_add_u32 v1, v31 offset:28
    s_mov_b64 exec, -1
    buffer_load_dwordx4 v15, s[48:51], s12 offen offset:3072 nt lds
    ds_read_b32 v30, v1 offset:4
    s_waitcnt lgkmcnt(0)
    v_cmp_gt_u32 vcc, 8, v30
    s_nop 0
    s_cbranch_vccz L_st_18_f4
    s_waitcnt vmcnt(3)
    s_add_u32 s21, s20, 4096
    s_and_b32 s21, s21, 0x3000
    s_add_u32 s13, s10, s21
    s_add_u32 s13, s13, 65536
    s_mov_b32 m0, s13
    s_add_u32 s12, s11, s21
    buffer_load_dwordx4 v14, s[48:51], s12 offen offset:0 nt lds
    ds_read_b32 v30, v1 offset:4
    s_waitcnt lgkmcnt(0)
    v_cmp_gt_u32 vcc, 8, v30
    s_nop 0
    s_cbranch_vccz L_st_18_f5
    s_waitcnt vmcnt(3)
    buffer_load_dwordx4 v15, s[48:51], s12 offen offset:1024 nt lds
    ds_read_b32 v30, v1 offset:4
    s_waitcnt lgkmcnt(0)
    v_cmp_gt_u32 vcc, 8, v30
    s_nop 0
    s_cbranch_vccz L_st_18_f6
    s_waitcnt vmcnt(3)
    buffer_load_dwordx4 v14, s[48:51], s12 offen offset:2048 nt lds
    ds_read_b32 v30, v1 offset:4
    s_waitcnt lgkmcnt(0)
    v_cmp_gt_u32 vcc, 8, v30
    s_nop 0
    s_cbranch_vccz L_st_18_f7
    s_waitcnt vmcnt(3)
    buffer_load_dwordx4 v15, s[48:51], s12 offen offset:3072 nt lds
    ds_read_b32 v30, v1 offset:4
    s_waitcnt lgkmcnt(0)
    v_cmp_gt_u32 vcc, 8, v30
    s_nop 0
    s_cbranch_vccz L_st_18_f8
    s_waitcnt vmcnt(3)
    s_add_u32 s21, s20, 8192
    s_and_b32 s21, s21, 0x3000
    s_add_u32 s13, s10, s21
    s_add_u32 s13, s13, 65536
    s_mov_b32 m0, s13
    s_add_u32 s12, s11, s21
    buffer_load_dwordx4 v14, s[48:51], s12 offen offset:0 nt lds
    ds_read_b32 v30, v1 offset:4
    s_waitcnt lgkmcnt(0)
    v_cmp_gt_u32 vcc, 8, v30
    s_nop 0
    s_cbranch_vccz L_st_18_f9
    s_waitcnt vmcnt(3)
    buffer_load_dwordx4 v15, s[48:51], s12 offen offset:1024 nt lds
    ds_read_b32 v30, v1 offset:4
    s_waitcnt lgkmcnt(0)
    v_cmp_gt_u32 vcc, 8, v30
    s_nop 0
    s_cbranch_vccz L_st_18_f10
    s_waitcnt vmcnt(3)
    buffer_load_dwordx4 v14, s[48:51], s12 offen offset:2048 nt lds
    ds_read_b32 v30, v1 offset:4
    s_waitcnt lgkmcnt(0)
    v_cmp_gt_u32 vcc, 8, v30
    s_nop 0
    s_cbranch_vccz L_st_18_f11
    s_waitcnt vmcnt(3)
    buffer_load_dwordx4 v15, s[48:51], s12 offen offset:3072 nt lds
    ds_read_b32 v30, v1 offset:4
    s_waitcnt lgkmcnt(0)
    v_cmp_gt_u32 vcc, 8, v30
    s_nop 0
    s_cbranch_vccz L_st_18_f12
    s_waitcnt vmcnt(3)
    s_add_u32 s21, s20, 12288
    s_and_b32 s21, s21, 0x3000
    s_add_u32 s13, s10, s21
    s_add_u32 s13, s13, 65536
    s_mov_b32 m0, s13
    s_add_u32 s12, s11, s21
    buffer_load_dwordx4 v14, s[48:51], s12 offen offset:0 nt lds
    ds_read_b32 v30, v1 offset:4
    s_waitcnt lgkmcnt(0)
    v_cmp_gt_u32 vcc, 8, v30
    s_nop 0
    s_cbranch_vccz L_st_18_f13
    s_waitcnt vmcnt(3)
    buffer_load_dwordx4 v15, s[48:51], s12 offen offset:1024 nt lds
    ds_read_b32 v30, v1 offset:4
    s_waitcnt lgkmcnt(0)
    v_cmp_gt_u32 vcc, 8, v30
    s_nop 0
    s_cbranch_vccz L_st_18_f14
    s_waitcnt vmcnt(3)
    buffer_load_dwordx4 v14, s[48:51], s12 offen offset:2048 nt lds
    ds_read_b32 v30, v1 offset:4
    s_waitcnt lgkmcnt(0)
    v_cmp_gt_u32 vcc, 8, v30
    s_nop 0
    s_cbranch_vccz L_st_18_f15
    s_waitcnt vmcnt(3)
    buffer_load_dwordx4 v15, s[48:51], s12 offen offset:3072 nt lds
    s_branch L_st_18_done
L_st_18_f4:
    s_add_u32 s21, s20, 4096
    s_and_b32 s21, s21, 0x3000
    s_add_u32 s13, s10, s21
    s_add_u32 s13, s13, 65536
    s_mov_b32 m0, s13
    s_add_u32 s12, s11, s21
    buffer_load_dwordx4 v14, s[48:51], s12 offen offset:0 nt lds
L_st_18_f5:
    buffer_load_dwordx4 v15, s[48:51], s12 offen offset:1024 nt lds
L_st_18_f6:
    buffer_load_dwordx4 v14, s[48:51], s12 offen offset:2048 nt lds
L_st_18_f7:
    buffer_load_dwordx4 v15, s[48:51], s12 offen offset:3072 nt lds
L_st_18_f8:
    s_add_u32 s21, s20, 8192
    s_and_b32 s21, s21, 0x3000
    s_add_u32 s13, s10, s21
    s_add_u32 s13, s13, 65536
    s_mov_b32 m0, s13
    s_add_u32 s12, s11, s21
    buffer_load_dwordx4 v14, s[48:51], s12 offen offset:0 nt lds
L_st_18_f9:
    buffer_load_dwordx4 v15, s[48:51], s12 offen offset:1024 nt lds
L_st_18_f10:
    buffer_load_dwordx4 v14, s[48:51], s12 offen offset:2048 nt lds
L_st_18_f11:
    buffer_load_dwordx4 v15, s[48:51], s12 offen offset:3072 nt lds
L_st_18_f12:
    s_add_u32 s21, s20, 12288
    s_and_b32 s21, s21, 0x3000
    s_add_u32 s13, s10, s21
    s_add_u32 s13, s13, 65536
    s_mov_b32 m0, s13
    s_add_u32 s12, s11, s21
    buffer_load_dwordx4 v14, s[48:51], s12 offen offset:0 nt lds
L_st_18_f13:
    buffer_load_dwordx4 v15, s[48:51], s12 offen offset:1024 nt lds
L_st_18_f14:
    buffer_load_dwordx4 v14, s[48:51], s12 offen offset:2048 nt lds
L_st_18_f15:
    buffer_load_dwordx4 v15, s[48:51], s12 offen offset:3072 nt lds
L_st_18_done:
    s_mov_b32 s8, 1
    s_mov_b32 s9, s5
    s_cmp_lt_u32 s5, 16
    s_cbranch_scc1 L_role_19
    s_mov_b32 s8, 2
    s_and_b32 s9, s5, 7
    s_cmp_lt_u32 s5, 24
    s_cbranch_scc1 L_role_19
    s_mov_b32 s8, 3
    s_cmp_lt_u32 s9, 4
    s_cbranch_scc1 L_role_19
    s_mov_b32 s8, 4
    s_cmp_lt_u32 s9, 6
    s_cbranch_scc1 L_role_19
    s_mov_b32 s8, 0
L_role_19:
    s_lshl_b32 s13, s3, 13
    s_cmp_eq_u32 s8, 1
    s_cbranch_scc1 L_ld_b
    s_cmp_eq_u32 s8, 2
    s_cbranch_scc1 L_ld_r
    s_cmp_eq_u32 s8, 3
    s_cbranch_scc1 L_ld_c
    s_waitcnt vmcnt(0)
    s_barrier
    s_branch L_ld_exit
L_ld_b:
    s_mov_b32 s52, s24
    s_mov_b32 s53, s25
    s_mov_b32 s54, 0x400000
    s_mov_b32 s55, 0x20000
    v_lshlrev_b32 v23, 1, v3
    v_xor_b32 v23, v23, v4
    v_lshlrev_b32 v28, 10, v3
    v_lshl_add_u32 v24, v23, 4, v28
    v_xor_b32 v23, 8, v23
    v_lshl_add_u32 v25, v23, 4, v28
    v_mov_b32 v26, v24
    v_mov_b32 v27, v25
    s_lshl_b32 s12, s4, 19
    s_lshr_b32 s14, s9, 2
    s_lshl_b32 s14, s14, 17
    s_add_u32 s12, s12, s14
    s_and_b32 s14, s9, 3
    s_lshl_b32 s14, s14, 8
    s_add_u32 s12, s12, s14
    s_lshl_b32 s14, s3, 15
    s_add_u32 s12, s12, s14
    s_movk_i32 s14, 4096
    s_mov_b32 s26, 0
    s_branch L_ld_go
L_ld_r:
    s_mov_b32 s52, s28
    s_mov_b32 s53, s29
    s_mov_b32 s54, 0x1c0000
    s_mov_b32 s55, 0x20000
    v_lshrrev_b32 v23, 5, v2
    v_mul_u32_u24 v28, 3584, v23
    v_lshlrev_b32 v23, 1, v23
    v_and_b32 v29, 31, v2
    v_xor_b32 v23, v23, v29
    v_lshl_add_u32 v24, v23, 4, v28
    v_xor_b32 v29, 4, v23
    v_lshl_add_u32 v25, v29, 4, v28
    v_xor_b32 v29, 8, v23
    v_lshl_add_u32 v26, v29, 4, v28
    v_xor_b32 v29, 12, v23
    v_lshl_add_u32 v27, v29, 4, v28
    s_lshl_b32 s12, s9, 2
    s_add_u32 s12, s12, s3
    s_mul_i32 s12, s12, 57344
    s_mul_i32 s14, s4, 448
    s_add_u32 s12, s12, s14
    s_movk_i32 s14, 7168
    s_mov_b32 s26, 0
    s_branch L_ld_go
L_ld_c:
    s_mov_b32 s52, s32
    s_mov_b32 s53, s33
    s_mov_b32 s54, 0x1c0000
    s_mov_b32 s55, 0x20000
    v_lshl_add_u32 v24, v5, 10, v6
    v_mov_b32 v25, v24
    v_mov_b32 v26, v24
    v_mov_b32 v27, v24
    s_lshl_b32 s12, s4, 2
    s_add_u32 s12, s12, s9
    s_mul_i32 s12, s12, 57344
    s_lshl_b32 s14, s3, 8
    s_add_u32 s12, s12, s14
    s_movk_i32 s14, 8192
    s_mov_b32 s26, 0
    s_lshl_b32 s13, s3, 14
L_ld_go:
    s_lshr_b32 s27, 12, s8
    s_and_b32 s27, s27, 1
    s_cbranch_scc0 L_ld_early
    s_waitcnt vmcnt(0)
    s_barrier
L_sb_20:
    ds_read_b32 v30, v1 offset:24
    s_waitcnt lgkmcnt(0)
    v_cmp_gt_u32 vcc, 8, v30
    s_nop 0
    s_cbranch_vccz L_sb_20d
    s_add_u32 s15, s15, 1
    s_cmp_gt_u32 s15, 100000
    s_cbranch_scc1 L_sb_20d
    s_branch L_sb_20
L_sb_20d:
    s_mov_b32 m0, s13
    s_add_u32 s13, s13, 1024
    buffer_load_dwordx4 v24, s[52:55], s12 offen nt lds
    s_add_u32 s12, s12, s14
    s_mov_b32 m0, s13
    s_add_u32 s13, s13, 1024
    buffer_load_dwordx4 v25, s[52:55], s12 offen nt lds
    s_add_u32 s12, s12, s14
    s_mov_b32 m0, s13
    s_add_u32 s13, s13, 1024
    buffer_load_dwordx4 v26, s[52:55], s12 offen nt lds
    s_add_u32 s12, s12, s14
    s_mov_b32 m0, s13
    s_add_u32 s13, s13, 1024
    buffer_load_dwordx4 v27, s[52:55], s12 offen nt lds
    s_add_u32 s12, s12, s14
    s_add_u32 s12, s12, s26
    s_mov_b32 m0, s13
    s_add_u32 s13, s13, 1024
    buffer_load_dwordx4 v24, s[52:55], s12 offen nt lds
    s_add_u32 s12, s12, s14
    s_mov_b32 m0, s13
    s_add_u32 s13, s13, 1024
    buffer_load_dwordx4 v25, s[52:55], s12 offen nt lds
    s_add_u32 s12, s12, s14
    s_mov_b32 m0, s13
    s_add_u32 s13, s13, 1024
    buffer_load_dwordx4 v26, s[52:55], s12 offen nt lds
    s_add_u32 s12, s12, s14
    s_mov_b32 m0, s13
    s_add_u32 s13, s13, 1024
    buffer_load_dwordx4 v27, s[52:55], s12 offen nt lds
    s_add_u32 s12, s12, s14
    s_cmp_eq_u32 s8, 3
    s_cbranch_scc0 L_ld_fin
    s_add_u32 s12, s12, -65408
    s_mov_b32 m0, s13
    s_add_u32 s13, s13, 1024
    buffer_load_dwordx4 v24, s[52:55], s12 offen nt lds
    s_add_u32 s12, s12, s14
    s_mov_b32 m0, s13
    s_add_u32 s13, s13, 1024
    buffer_load_dwordx4 v25, s[52:55], s12 offen nt lds
    s_add_u32 s12, s12, s14
    s_mov_b32 m0, s13
    s_add_u32 s13, s13, 1024
    buffer_load_dwordx4 v26, s[52:55], s12 offen nt lds
    s_add_u32 s12, s12, s14
    s_mov_b32 m0, s13
    s_add_u32 s13, s13, 1024
    buffer_load_dwordx4 v27, s[52:55], s12 offen nt lds
    s_add_u32 s12, s12, s14
    s_add_u32 s12, s12, s26
    s_mov_b32 m0, s13
    s_add_u32 s13, s13, 1024
    buffer_load_dwordx4 v24, s[52:55], s12 offen nt lds
    s_add_u32 s12, s12, s14
    s_mov_b32 m0, s13
    s_add_u32 s13, s13, 1024
    buffer_load_dwordx4 v25, s[52:55], s12 offen nt lds
    s_add_u32 s12, s12, s14
    s_mov_b32 m0, s13
    s_add_u32 s13, s13, 1024
    buffer_load_dwordx4 v26, s[52:55], s12 offen nt lds
    s_add_u32 s12, s12, s14
    s_mov_b32 m0, s13
    s_add_u32 s13, s13, 1024
    buffer_load_dwordx4 v27, s[52:55], s12 offen nt lds
    s_add_u32 s12, s12, s14
    s_branch L_ld_fin
L_ld_early:
L_sb_21:
    ds_read_b32 v30, v1 offset:8
    s_waitcnt lgkmcnt(0)
    v_cmp_gt_u32 vcc, 8, v30
    s_nop 0
    s_cbranch_vccz L_sb_21d
    s_add_u32 s15, s15, 1
    s_cmp_gt_u32 s15, 100000
    s_cbranch_scc1 L_sb_21d
    s_branch L_sb_21
L_sb_21d:
    s_mov_b32 m0, s13
    s_add_u32 s13, s13, 1024
    buffer_load_dwordx4 v24, s[52:55], s12 offen nt lds
    s_add_u32 s12, s12, s14
    s_mov_b32 m0, s13
    s_add_u32 s13, s13, 1024
    buffer_load_dwordx4 v25, s[52:55], s12 offen nt lds
    s_add_u32 s12, s12, s14
    s_mov_b32 m0, s13
    s_add_u32 s13, s13, 1024
    buffer_load_dwordx4 v26, s[52:55], s12 offen nt lds
    s_add_u32 s12, s12, s14
    s_mov_b32 m0, s13
    s_add_u32 s13, s13, 1024
    buffer_load_dwordx4 v27, s[52:55], s12 offen nt lds
    s_add_u32 s12, s12, s14
    s_add_u32 s12, s12, s26
    s_mov_b32 m0, s13
    s_add_u32 s13, s13, 1024
    buffer_load_dwordx4 v24, s[52:55], s12 offen nt lds
    s_add_u32 s12, s12, s14
    s_mov_b32 m0, s13
    s_add_u32 s13, s13, 1024
    buffer_load_dwordx4 v25, s[52:55], s12 offen nt lds
    s_add_u32 s12, s12, s14
    s_mov_b32 m0, s13
    s_add_u32 s13, s13, 1024
    buffer_load_dwordx4 v26, s[52:55], s12 offen nt lds
    s_add_u32 s12, s12, s14
    s_mov_b32 m0, s13
    s_add_u32 s13, s13, 1024
    buffer_load_dwordx4 v27, s[52:55], s12 offen nt lds
    s_add_u32 s12, s12, s14
    s_waitcnt vmcnt(8)
    s_barrier
L_ld_fin:
    s_waitcnt vmcnt(0)
    s_mov_b64 exec, 1
    ds_add_u32 v1, v31 offset:16
    s_mov_b64 exec, -1
L_ld_exit:
    s_endpgm
.section .rodata,"a"
.p2align 6
.amdhsa_kernel sequential_preLN__sliding_block_cached__mixer_channel_mlp__decode_kernel
  .amdhsa_next_free_vgpr 168
  .amdhsa_next_free_sgpr 100
  .amdhsa_accum_offset 168
  .amdhsa_group_segment_fixed_size 0
  .amdhsa_kernarg_size 104
  .amdhsa_user_sgpr_count 2
  .amdhsa_user_sgpr_kernarg_segment_ptr 1
  .amdhsa_system_sgpr_workgroup_id_x 1
  .amdhsa_float_denorm_mode_32 3
.end_amdhsa_kernel
```
